```python
import torch

def _softmax(x, axis=-1):
    return torch.softmax(x, dim=axis)
def _gelu(x):
    return torch.nn.functional.gelu(x, approximate="tanh")
def _silu(x):
    return torch.nn.functional.silu(x)
def _sigmoid(x):
    return torch.sigmoid(x)
def _layernorm(x, axis=-1, eps=1e-5):
    m = x.mean(dim=axis, keepdim=True)
    v = x.var(dim=axis, keepdim=True, unbiased=False)
    return (x - m) / torch.sqrt(v + eps)
def _scatter_add(tgt, idx, src, axis=0):
    return tgt.clone().index_add_(axis, idx, src)
def _segment_sum(src, seg, n):
    out = torch.zeros((n,) + src.shape[1:], dtype=src.dtype)
    return out.index_add_(0, seg, src)
def _pad(x, pw):
    flat = tuple(v for pair in reversed(pw) for v in pair)
    return torch.nn.functional.pad(x, flat)

kernel_name = 'sequential_preLN__gqa_block_cached__geglu_ffn__decode'

def setup_inputs():

    _w = (lambda a: (lambda t: t.to(torch.bfloat16) if t.is_floating_point() else t)(torch.as_tensor(a)))
    def _A_setup():
        B, Sq, D = 4, 1, 512
        Hq, Hkv, Sk, Dh = 32, 8, 16384, 128
        assert Hq % Hkv == 0, (Hq, Hkv)
        return {
            "x": _w((lambda *s: torch.randn(*s, dtype=torch.bfloat16) * 0.05)(B, Sq, D)),
            "k_cache": _w((lambda *s: torch.randn(*s, dtype=torch.bfloat16) * 3.2)(B, Hkv, Sk, Dh)),
            "v_cache": _w((lambda *s: torch.randn(*s, dtype=torch.bfloat16) * 0.4)(B, Hkv, Sk, Dh)),
            "wq": _w((lambda *s: torch.randn(*s, dtype=torch.bfloat16) * 3.2)(D, Hq * Dh) * (D ** -0.5)),
            "wo": _w((lambda *s: torch.randn(*s, dtype=torch.bfloat16) * 0.4)(Hq * Dh, D) * ((Hq * Dh) ** -0.5)),
        }
    _A_in = _A_setup()

    def _B_setup():
        B, S, D, F = 4, 1, 512, 1792
        return {
            "x": _w((lambda *s: torch.randn(*s, dtype=torch.bfloat16) * 0.05)(B, S, D)),
            "w_gate": _w((lambda *s: torch.randn(*s, dtype=torch.bfloat16) * 0.05)(D, F)),
            "w_up": _w((lambda *s: torch.randn(*s, dtype=torch.bfloat16) * 0.05)(D, F)),
            "w_down": _w((lambda *s: torch.randn(*s, dtype=torch.bfloat16) * 0.05)(F, D)),
        }
    _B_in = _B_setup()

    return {
        "A_x": _A_in["x"],
        "A_k_cache": _A_in["k_cache"],
        "A_v_cache": _A_in["v_cache"],
        "A_wq": _A_in["wq"],
        "A_wo": _A_in["wo"],
        "B_x": _B_in["x"],
        "B_w_gate": _B_in["w_gate"],
        "B_w_up": _B_in["w_up"],
        "B_w_down": _B_in["w_down"],
    }

def reference(A_x, A_k_cache, A_v_cache, A_wq, A_wo, B_x, B_w_gate, B_w_up, B_w_down):
    def _A_ref(x, k_cache, v_cache, wq, wo):
        B, Sq, D = x.shape
        Hq, Dh = 32, 128
        Hkv = k_cache.shape[1]
        rep = Hq // Hkv
        q = (lambda x, *d: x.permute(*d))((x @ wq).reshape(B, Sq, Hq, Dh), 0, 2, 1, 3)
        k = (lambda x, n, axis: torch.repeat_interleave(x, n, dim=axis))(k_cache, rep, axis=1)
        v = (lambda x, n, axis: torch.repeat_interleave(x, n, dim=axis))(v_cache, rep, axis=1)
        scores = torch.einsum("bhqd,bhkd->bhqk", q, k) * (Dh ** -0.5)
        p = _softmax(scores, axis=-1)
        o = torch.einsum("bhqk,bhkd->bhqd", p, v)
        return (lambda x, *d: x.permute(*d))(o, 0, 2, 1, 3).reshape(B, Sq, Hq * Dh) @ wo

    def _B_ref(x, w_gate, w_up, w_down):
        return (_gelu(x @ w_gate) * (x @ w_up)) @ w_down

    x = A_x
    h = x + _A_ref(_layernorm(x, axis=-1), A_k_cache, A_v_cache, A_wq, A_wo)
    h2 = h + _B_ref(_layernorm(h, axis=-1), B_w_gate, B_w_up, B_w_down)
    return h2
```

```asm
; @launch grid=(256,1,1) block=(576,1,1) lds=163840
.amdgcn_target "amdgcn-amd-amdhsa--gfx950"
.text
.globl sequential_preLN__gqa_block_cached__geglu_ffn__decode_kernel
.p2align 8
.type sequential_preLN__gqa_block_cached__geglu_ffn__decode_kernel,@function
sequential_preLN__gqa_block_cached__geglu_ffn__decode_kernel:
    s_cmp_ge_u32 s2, 256
    s_cbranch_scc1 L_end
    s_load_dwordx16 s[64:79], s[0:1], 0
    s_load_dwordx8 s[80:87], s[0:1], 64
    v_and_b32 v1, 63, v0
    v_lshrrev_b32 v2, 6, v0
    s_nop 0
    v_readfirstlane_b32 s3, v2
    s_nop 0
    s_cmp_lg_u32 s3, 3
    s_cbranch_scc1 L_nocpf
    s_getpc_b64 s[58:59]
L_pc0:
    s_nop 7
    s_nop 3
    v_lshlrev_b32 v4, 7, v1
    v_min_u32 v5, L_end-L_pc0, v4
    global_load_dword v20, v5, s[58:59]
    v_add_u32 v4, 0x2000, v4
    v_min_u32 v5, L_end-L_pc0, v4
    global_load_dword v21, v5, s[58:59]
    v_add_u32 v4, 0x2000, v4
    v_min_u32 v5, L_end-L_pc0, v4
    global_load_dword v22, v5, s[58:59]
    v_add_u32 v4, 0x2000, v4
L_nocpf:
    s_nop 7
    s_nop 3
    v_and_b32 v2, 15, v1
    v_lshrrev_b32 v3, 4, v1
    s_lshr_b32 s11, s2, 3
    s_and_b32 s12, s11, 3
    s_lshr_b32 s13, s11, 2
    s_add_u32 s10, s2, s13
    s_and_b32 s10, s10, 7
    s_lshl_b32 s2, s11, 3
    s_or_b32 s2, s2, s10
    s_lshl_b32 s7, s12, 3
    s_add_u32 s7, s7, s10
    s_lshl_b32 s7, s7, 22
    s_mov_b32 s98, 0x3db504f3
    s_mov_b32 s99, 0x3fb8aa3b
    s_lshl_b32 s14, s10, 2
    s_add_u32 s14, s14, s12
    s_lshl_b32 s14, s14, 3
    s_add_u32 s14, s14, s13
    s_mul_i32 s15, s10, 14
    s_add_u32 s15, s15, s11
    s_sub_u32 s15, s15, 16
    s_sub_u32 s56, s11, 30
    s_lshl_b32 s56, s56, 3
    s_add_u32 s56, s56, s10
    s_cmp_ge_u32 s11, 30
    s_cselect_b32 s15, s56, s15
    v_lshlrev_b32 v6, 4, v1
    s_sub_u32 s6, s3, 4
    s_lshl_b32 s97, s6, 14
    s_add_u32 s97, s97, 16384
    s_waitcnt lgkmcnt(0)
    s_mov_b32 s24, s86
    s_and_b32 s25, s87, 0xffff
    s_mov_b32 s26, 1769472
    s_mov_b32 s27, 0x00020000
    s_cmp_lg_u32 s3, 0
    s_cbranch_scc1 L_nw0
    v_lshrrev_b32 v4, 1, v1
    v_lshlrev_b32 v4, 13, v4
    v_and_b32 v5, 1, v1
    v_lshl_add_u32 v4, v5, 4, v4
    s_lshl_b32 s56, s10, 10
    s_lshl_b32 s57, s11, 5
    s_add_u32 s56, s56, s57
    s_mov_b32 s52, s70
    s_and_b32 s53, s71, 0xffff
    s_mov_b32 s54, 4194304
    s_mov_b32 s55, 0x00020000
    buffer_load_dwordx4 v[28:31], v4, s[52:55], s56 offen
    s_add_u32 s56, s56, 262144
    buffer_load_dwordx4 v[32:35], v4, s[52:55], s56 offen
    s_add_u32 s56, s56, 262144
    buffer_load_dwordx4 v[36:39], v4, s[52:55], s56 offen
    s_add_u32 s56, s56, 262144
    buffer_load_dwordx4 v[40:43], v4, s[52:55], s56 offen
    s_add_u32 s56, s56, 262144
    buffer_load_dwordx4 v[44:47], v4, s[52:55], s56 offen
    s_add_u32 s56, s56, 262144
    buffer_load_dwordx4 v[48:51], v4, s[52:55], s56 offen
    s_add_u32 s56, s56, 262144
    buffer_load_dwordx4 v[52:55], v4, s[52:55], s56 offen
    s_add_u32 s56, s56, 262144
    buffer_load_dwordx4 v[56:59], v4, s[52:55], s56 offen
    s_add_u32 s56, s56, 262144
    buffer_load_dwordx4 v[60:63], v4, s[52:55], s56 offen
    s_add_u32 s56, s56, 262144
    buffer_load_dwordx4 v[64:67], v4, s[52:55], s56 offen
    s_add_u32 s56, s56, 262144
    buffer_load_dwordx4 v[68:71], v4, s[52:55], s56 offen
    s_add_u32 s56, s56, 262144
    buffer_load_dwordx4 v[72:75], v4, s[52:55], s56 offen
    s_add_u32 s56, s56, 262144
    buffer_load_dwordx4 v[76:79], v4, s[52:55], s56 offen
    s_add_u32 s56, s56, 262144
    buffer_load_dwordx4 v[80:83], v4, s[52:55], s56 offen
    s_add_u32 s56, s56, 262144
    buffer_load_dwordx4 v[84:87], v4, s[52:55], s56 offen
    s_add_u32 s56, s56, 262144
    buffer_load_dwordx4 v[88:91], v4, s[52:55], s56 offen
    v_mov_b32 v12, -1
    v_mov_b32 v13, -1
    v_mov_b32 v14, -1
    v_mov_b32 v15, -1
    s_lshl_b32 s56, s14, 11
    s_add_u32 s56, s56, 65536
    buffer_store_dwordx4 v[12:15], v6, s[24:27], s56 offen sc1
    buffer_store_dwordx4 v[12:15], v6, s[24:27], s56 offen offset:1024 sc1
    v_lshrrev_b32 v4, 3, v1
    v_lshlrev_b32 v4, 11, v4
    v_and_b32 v5, 7, v1
    v_lshl_add_u32 v4, v5, 4, v4
    s_lshl_b32 s56, s10, 13
    s_lshl_b32 s57, s11, 7
    s_add_u32 s56, s56, s57
    s_add_u32 s56, s56, 655360
    v_add_u32 v4, s56, v4
    s_lshl_b32 s56, s14, 5
    s_add_u32 s56, s56, 589312
    v_add_u32 v5, s56, v6
    v_cmp_gt_u32 vcc, 32, v1
    s_nop 1
    v_cndmask_b32 v4, v5, v4, vcc
    s_lshl_b32 s56, s2, 7
    s_add_u32 s56, s56, 32768
    v_mov_b32 v5, s56
    v_cmp_eq_u32 vcc, 34, v1
    s_nop 1
    v_cndmask_b32 v4, v4, v5, vcc
    s_lshr_b32 s56, s14, 3
    s_lshl_b32 s56, s56, 7
    s_add_u32 s56, s56, 1736704
    s_sub_u32 s56, s56, 560
    v_add_u32 v5, s56, v6
    v_cmp_lt_u32 vcc, 34, v1
    s_nop 1
    v_cndmask_b32 v4, v4, v5, vcc
    v_mov_b32 v8, -1
    v_mov_b32 v9, -1
    v_mov_b32 v10, -1
    v_mov_b32 v11, -1
    s_cmp_eq_u32 s13, 0
    s_cselect_b32 s61, 31, 7
    s_cmp_lt_u32 s11, 16
    s_cselect_b32 s60, -1, 0
    s_mov_b64 exec, s[60:61]
    buffer_store_dwordx4 v[8:11], v4, s[24:27], 0 offen sc1
    s_mov_b64 exec, -1
    s_lshl_b32 s56, s15, 13
    s_add_u32 s56, s56, 786432
    s_mov_b32 s57, 0
    s_cmp_lt_u32 s11, 16
    s_cselect_b32 s57, 1769472, s57
    s_cselect_b32 s56, 0, s56
    s_cmp_ge_u32 s11, 30
    s_cselect_b32 s57, 1769472, s57
    s_cselect_b32 s56, 0, s56
    v_add_u32 v7, s57, v6
    buffer_store_dwordx4 v[12:15], v7, s[24:27], s56 offen offset:0 sc1
    buffer_store_dwordx4 v[12:15], v7, s[24:27], s56 offen offset:1024 sc1
    buffer_store_dwordx4 v[12:15], v7, s[24:27], s56 offen offset:2048 sc1
    buffer_store_dwordx4 v[12:15], v7, s[24:27], s56 offen offset:3072 sc1
    s_add_u32 s56, s56, 4096
    buffer_store_dwordx4 v[12:15], v7, s[24:27], s56 offen offset:0 sc1
    buffer_store_dwordx4 v[12:15], v7, s[24:27], s56 offen offset:1024 sc1
    buffer_store_dwordx4 v[12:15], v7, s[24:27], s56 offen offset:2048 sc1
    buffer_store_dwordx4 v[12:15], v7, s[24:27], s56 offen offset:3072 sc1
    s_branch L_b0
L_nw0:
    s_nop 7
    s_nop 3
    s_mov_b32 s28, s64
    s_and_b32 s29, s65, 0xffff
    s_mov_b32 s30, 4096
    s_mov_b32 s31, 0x00020000
    s_and_b32 s63, s3, 3
    s_lshl_b32 s63, s63, 10
    s_lshr_b32 s56, s3, 2
    s_cmp_lg_u32 s56, 1
    s_cbranch_scc1 L_nox
    buffer_load_dwordx4 v[24:27], v6, s[28:31], s63 offen
L_nox:
    s_nop 7
    s_nop 3
    s_cmp_lg_u32 s3, 1
    s_cbranch_scc1 L_b0
    v_and_b32 v4, 1, v1
    v_cmp_eq_u32 vcc, 1, v4
    v_cmp_gt_u32 s[58:59], 18, v1
    s_nop 0
    s_and_b64 vcc, vcc, s[58:59]
    v_mov_b32 v4, 0
    v_mov_b32 v5, 0x7fffffff
    v_cndmask_b32 v4, v4, v5, vcc
    v_subrev_u32 v5, 32, v1
    v_cmp_lt_u32 vcc, -9, v5
    s_nop 1
    v_cndmask_b32 v4, v4, v5, vcc
    v_lshlrev_b32 v5, 2, v1
    ds_write_b32 v5, v4 offset:15744
    s_waitcnt lgkmcnt(0)
L_b0:
    s_nop 7
    s_nop 3
    s_mov_b32 s28, s64
    s_and_b32 s29, s65, 0xffff
    s_mov_b32 s30, 4096
    s_mov_b32 s31, 0x00020000
    s_add_u32 s16, s66, s7
    s_addc_u32 s17, s67, 0
    s_and_b32 s17, s17, 0xffff
    s_mov_b32 s18, 0x400000
    s_mov_b32 s19, 0x00020000
    s_add_u32 s20, s68, s7
    s_addc_u32 s21, s69, 0
    s_and_b32 s21, s21, 0xffff
    s_mov_b32 s22, 0x400000
    s_mov_b32 s23, 0x00020000
    s_mov_b32 s32, s72
    s_and_b32 s33, s73, 0xffff
    s_mov_b32 s34, 4194304
    s_mov_b32 s35, 0x00020000
    s_mov_b32 s36, s78
    s_and_b32 s37, s79, 0xffff
    s_mov_b32 s38, 1835008
    s_mov_b32 s39, 0x00020000
    s_mov_b32 s40, s80
    s_and_b32 s41, s81, 0xffff
    s_mov_b32 s42, 1835008
    s_mov_b32 s43, 0x00020000
    s_mov_b32 s44, s82
    s_and_b32 s45, s83, 0xffff
    s_mov_b32 s46, 4096
    s_mov_b32 s47, 0x00020000
    s_mov_b32 s4, s84
    s_mov_b32 s5, s85
    s_mov_b32 s8, s86
    s_mov_b32 s9, s87
    s_cmp_lt_u32 s11, 16
    s_cbranch_scc1 L_p1
    s_mov_b32 s32, s76
    s_and_b32 s33, s77, 0xffff
    s_mov_b32 s34, 1835008
    s_mov_b32 s35, 0x00020000
L_p1:
    s_nop 7
    s_nop 3
    v_mov_b32 v9, 0
    s_mov_b64 s[50:51], -1
    s_barrier
    s_cmp_eq_u32 s3, 8
    s_cbranch_scc1 L_loader
    s_cmp_eq_u32 s3, 0
    s_cbranch_scc1 L_w0q
    s_cmp_lt_u32 s3, 4
    s_cbranch_scc1 L_qwait
    s_waitcnt vmcnt(0)
    v_lshlrev_b32 v28, 16, v24
    v_and_b32 v29, 0xffff0000, v24
    v_lshlrev_b32 v30, 16, v25
    v_and_b32 v31, 0xffff0000, v25
    v_lshlrev_b32 v32, 16, v26
    v_and_b32 v33, 0xffff0000, v26
    v_lshlrev_b32 v34, 16, v27
    v_and_b32 v35, 0xffff0000, v27
    v_add_f32 v36, v28, v29
    v_add_f32 v36, v36, v30
    v_add_f32 v36, v36, v31
    v_add_f32 v36, v36, v32
    v_add_f32 v36, v36, v33
    v_add_f32 v36, v36, v34
    v_add_f32 v36, v36, v35
    s_nop 1
    v_add_f32_dpp v36, v36, v36 quad_perm:[1,0,3,2] row_mask:0xf bank_mask:0xf
    s_nop 1
    v_add_f32_dpp v36, v36, v36 quad_perm:[2,3,0,1] row_mask:0xf bank_mask:0xf
    s_nop 1
    v_add_f32_dpp v36, v36, v36 row_half_mirror row_mask:0xf bank_mask:0xf
    s_nop 1
    v_add_f32_dpp v36, v36, v36 row_mirror row_mask:0xf bank_mask:0xf
    v_mov_b32 v37, v36
    s_nop 1
    v_permlane16_swap_b32 v36, v37
    v_add_f32 v36, v36, v37
    v_mov_b32 v37, v36
    s_nop 1
    v_permlane32_swap_b32 v36, v37
    v_add_f32 v36, v36, v37
    v_mul_f32 v36, 0x3b000000, v36
    v_sub_f32 v37, v28, v36
    v_mul_f32 v38, v37, v37
    v_sub_f32 v37, v29, v36
    v_fmac_f32 v38, v37, v37
    v_sub_f32 v37, v30, v36
    v_fmac_f32 v38, v37, v37
    v_sub_f32 v37, v31, v36
    v_fmac_f32 v38, v37, v37
    v_sub_f32 v37, v32, v36
    v_fmac_f32 v38, v37, v37
    v_sub_f32 v37, v33, v36
    v_fmac_f32 v38, v37, v37
    v_sub_f32 v37, v34, v36
    v_fmac_f32 v38, v37, v37
    v_sub_f32 v37, v35, v36
    v_fmac_f32 v38, v37, v37
    s_nop 1
    v_add_f32_dpp v38, v38, v38 quad_perm:[1,0,3,2] row_mask:0xf bank_mask:0xf
    s_nop 1
    v_add_f32_dpp v38, v38, v38 quad_perm:[2,3,0,1] row_mask:0xf bank_mask:0xf
    s_nop 1
    v_add_f32_dpp v38, v38, v38 row_half_mirror row_mask:0xf bank_mask:0xf
    s_nop 1
    v_add_f32_dpp v38, v38, v38 row_mirror row_mask:0xf bank_mask:0xf
    v_mov_b32 v37, v38
    s_nop 1
    v_permlane16_swap_b32 v38, v37
    v_add_f32 v38, v38, v37
    v_mov_b32 v37, v38
    s_nop 1
    v_permlane32_swap_b32 v38, v37
    v_add_f32 v38, v38, v37
    v_mul_f32 v38, 0x3b000000, v38
    v_cvt_pk_bf16_f32 v36, v36, v36
    v_lshlrev_b32 v36, 16, v36
    v_cvt_pk_bf16_f32 v38, v38, v38
    v_lshlrev_b32 v38, 16, v38
    v_add_f32 v38, 0x3727c5ac, v38
    v_cvt_pk_bf16_f32 v38, v38, v38
    v_lshlrev_b32 v38, 16, v38
    v_sqrt_f32 v38, v38
    s_nop 0
    v_cvt_pk_bf16_f32 v38, v38, v38
    v_lshlrev_b32 v38, 16, v38
    v_rcp_f32 v39, v38
    v_sub_f32 v28, v28, v36
    v_cvt_pk_bf16_f32 v28, v28, v28
    v_lshlrev_b32 v28, 16, v28
    v_mul_f32 v40, v28, v39
    v_fma_f32 v41, -v40, v38, v28
    v_fma_f32 v28, v41, v39, v40
    v_sub_f32 v29, v29, v36
    v_cvt_pk_bf16_f32 v29, v29, v29
    v_lshlrev_b32 v29, 16, v29
    v_mul_f32 v40, v29, v39
    v_fma_f32 v41, -v40, v38, v29
    v_fma_f32 v29, v41, v39, v40
    v_sub_f32 v30, v30, v36
    v_cvt_pk_bf16_f32 v30, v30, v30
    v_lshlrev_b32 v30, 16, v30
    v_mul_f32 v40, v30, v39
    v_fma_f32 v41, -v40, v38, v30
    v_fma_f32 v30, v41, v39, v40
    v_sub_f32 v31, v31, v36
    v_cvt_pk_bf16_f32 v31, v31, v31
    v_lshlrev_b32 v31, 16, v31
    v_mul_f32 v40, v31, v39
    v_fma_f32 v41, -v40, v38, v31
    v_fma_f32 v31, v41, v39, v40
    v_sub_f32 v32, v32, v36
    v_cvt_pk_bf16_f32 v32, v32, v32
    v_lshlrev_b32 v32, 16, v32
    v_mul_f32 v40, v32, v39
    v_fma_f32 v41, -v40, v38, v32
    v_fma_f32 v32, v41, v39, v40
    v_sub_f32 v33, v33, v36
    v_cvt_pk_bf16_f32 v33, v33, v33
    v_lshlrev_b32 v33, 16, v33
    v_mul_f32 v40, v33, v39
    v_fma_f32 v41, -v40, v38, v33
    v_fma_f32 v33, v41, v39, v40
    v_sub_f32 v34, v34, v36
    v_cvt_pk_bf16_f32 v34, v34, v34
    v_lshlrev_b32 v34, 16, v34
    v_mul_f32 v40, v34, v39
    v_fma_f32 v41, -v40, v38, v34
    v_fma_f32 v34, v41, v39, v40
    v_sub_f32 v35, v35, v36
    v_cvt_pk_bf16_f32 v35, v35, v35
    v_lshlrev_b32 v35, 16, v35
    v_mul_f32 v40, v35, v39
    v_fma_f32 v41, -v40, v38, v35
    v_fma_f32 v35, v41, v39, v40
    v_cvt_pk_bf16_f32 v24, v28, v29
    v_cvt_pk_bf16_f32 v25, v30, v31
    v_cvt_pk_bf16_f32 v26, v32, v33
    v_cvt_pk_bf16_f32 v27, v34, v35
    v_add_u32 v4, s63, v6
    ds_write_b128 v4, v[24:27] offset:8192
    v_mov_b32 v10, 1
    s_mov_b64 exec, 1
    ds_add_u32 v9, v10 offset:15816
    s_mov_b64 exec, -1
    v_lshrrev_b32 v4, 2, v2
    v_and_b32 v5, 3, v2
    v_lshl_add_u32 v6, v4, 3, v5
    v_lshlrev_b32 v6, 8, v6
    v_xor_b32 v7, v2, v3
    v_lshl_add_u32 v6, v7, 4, v6
    v_add_u32 v132, s97, v6
    v_xor_b32 v133, 0x40, v132
    v_xor_b32 v134, 0x80, v132
    v_xor_b32 v135, 0xc0, v132
    v_lshl_add_u32 v6, v3, 3, v4
    v_lshlrev_b32 v6, 8, v6
    v_and_b32 v7, 1, v3
    v_lshl_add_u32 v7, v7, 2, v4
    v_lshl_add_u32 v6, v7, 5, v6
    v_lshl_add_u32 v6, v5, 3, v6
    v_add_u32 v136, s97, v6
    v_xor_b32 v137, 0x20, v136
    v_xor_b32 v138, 0x40, v136
    v_xor_b32 v139, 0x60, v136
    v_xor_b32 v140, 0x80, v136
    v_xor_b32 v141, 0xa0, v136
    v_xor_b32 v142, 0xc0, v136
    v_xor_b32 v143, 0xe0, v136
    v_mov_b32 v24, 0
    v_mov_b32 v25, 0
    v_mov_b32 v26, 0
    v_mov_b32 v27, 0
    v_mov_b32 v28, 0
    v_mov_b32 v29, 0
    v_mov_b32 v30, 0
    v_mov_b32 v31, 0
    v_mov_b32 v32, 0
    v_mov_b32 v33, 0
    v_mov_b32 v34, 0
    v_mov_b32 v35, 0
    v_mov_b32 v36, 0
    v_mov_b32 v37, 0
    v_mov_b32 v38, 0
    v_mov_b32 v39, 0
    v_mov_b32 v40, 0
    v_mov_b32 v41, 0
    v_mov_b32 v42, 0
    v_mov_b32 v43, 0
    v_mov_b32 v44, 0
    v_mov_b32 v45, 0
    v_mov_b32 v46, 0
    v_mov_b32 v47, 0
    v_mov_b32 v48, 0
    v_mov_b32 v49, 0
    v_mov_b32 v50, 0
    v_mov_b32 v51, 0
    v_mov_b32 v52, 0
    v_mov_b32 v53, 0
    v_mov_b32 v54, 0
    v_mov_b32 v55, 0
    v_mov_b32 v144, 0xff7fffff
    v_mov_b32 v146, 0
    v_mov_b32 v148, 0
    s_branch L_qwait
L_w0q:
    s_nop 7
    s_nop 3
    v_lshrrev_b32 v4, 2, v2
    v_lshl_add_u32 v4, v3, 3, v4
    v_lshlrev_b32 v4, 5, v4
    v_and_b32 v5, 3, v2
    v_lshl_add_u32 v4, v5, 3, v4
    s_lshl_b32 s56, s3, 11
    s_add_u32 s56, s56, 0
    v_add_u32 v16, s56, v4
    v_lshlrev_b32 v4, 10, v5
    v_lshl_add_u32 v4, v3, 4, v4
    s_lshl_b32 s56, s3, 7
    s_add_u32 s56, s56, 8192
    v_add_u32 v17, s56, v4
    s_lshl_b32 s60, s10, 10
    s_lshl_b32 s57, s11, 5
    s_add_u32 s60, s60, s57
    s_lshl_b32 s61, s10, 5
    s_waitcnt vmcnt(19)
    ds_write_b128 v6, v[28:31] offset:0
    ds_write_b128 v6, v[32:35] offset:1024
    ds_write_b128 v6, v[36:39] offset:2048
    ds_write_b128 v6, v[40:43] offset:3072
    ds_write_b128 v6, v[44:47] offset:4096
    ds_write_b128 v6, v[48:51] offset:5120
    ds_write_b128 v6, v[52:55] offset:6144
    ds_write_b128 v6, v[56:59] offset:7168
    s_mov_b32 s62, 0
L_lwx:
    s_nop 7
    s_nop 3
    ds_read_b32 v10, v9 offset:15816
    s_waitcnt lgkmcnt(0)
    v_readfirstlane_b32 s56, v10
    s_nop 0
    s_cmp_eq_u32 s56, 4
    s_cbranch_scc1 L_lwdx
    s_sleep 1
    s_add_u32 s62, s62, 1
    s_cmp_lt_u32 s62, 1048576
    s_cbranch_scc1 L_lwx
L_lwdx:
    s_nop 7
    s_nop 3
    ds_read_b64_tr_b16 v[92:93], v16 offset:0
    ds_read_b64_tr_b16 v[94:95], v16 offset:128
    ds_read_b128 v[96:99], v17 offset:0
    ds_read_b64_tr_b16 v[100:101], v16 offset:1024
    ds_read_b64_tr_b16 v[102:103], v16 offset:1152
    ds_read_b128 v[104:107], v17 offset:64
    ds_read_b64_tr_b16 v[108:109], v16 offset:2048
    ds_read_b64_tr_b16 v[110:111], v16 offset:2176
    ds_read_b128 v[112:115], v17 offset:128
    ds_read_b64_tr_b16 v[116:117], v16 offset:3072
    ds_read_b64_tr_b16 v[118:119], v16 offset:3200
    ds_read_b128 v[120:123], v17 offset:192
    s_waitcnt lgkmcnt(9)
    v_mfma_f32_16x16x32_bf16 v[20:23], v[92:95], v[96:99], 0
    s_waitcnt lgkmcnt(6)
    v_mfma_f32_16x16x32_bf16 v[20:23], v[100:103], v[104:107], v[20:23]
    s_waitcnt lgkmcnt(3)
    v_mfma_f32_16x16x32_bf16 v[20:23], v[108:111], v[112:115], v[20:23]
    s_waitcnt lgkmcnt(0)
    v_mfma_f32_16x16x32_bf16 v[20:23], v[116:119], v[120:123], v[20:23]
    ds_read_b64_tr_b16 v[92:93], v16 offset:4096
    ds_read_b64_tr_b16 v[94:95], v16 offset:4224
    ds_read_b128 v[96:99], v17 offset:256
    ds_read_b64_tr_b16 v[100:101], v16 offset:5120
    ds_read_b64_tr_b16 v[102:103], v16 offset:5248
    ds_read_b128 v[104:107], v17 offset:320
    ds_read_b64_tr_b16 v[108:109], v16 offset:6144
    ds_read_b64_tr_b16 v[110:111], v16 offset:6272
    ds_read_b128 v[112:115], v17 offset:384
    ds_read_b64_tr_b16 v[116:117], v16 offset:7168
    ds_read_b64_tr_b16 v[118:119], v16 offset:7296
    ds_read_b128 v[120:123], v17 offset:448
    s_waitcnt lgkmcnt(9)
    v_mfma_f32_16x16x32_bf16 v[20:23], v[92:95], v[96:99], v[20:23]
    s_waitcnt lgkmcnt(6)
    v_mfma_f32_16x16x32_bf16 v[20:23], v[100:103], v[104:107], v[20:23]
    s_waitcnt lgkmcnt(3)
    v_mfma_f32_16x16x32_bf16 v[20:23], v[108:111], v[112:115], v[20:23]
    s_waitcnt lgkmcnt(0)
    v_mfma_f32_16x16x32_bf16 v[20:23], v[116:119], v[120:123], v[20:23]
    s_waitcnt vmcnt(11)
    ds_write_b128 v6, v[60:63] offset:0
    ds_write_b128 v6, v[64:67] offset:1024
    ds_write_b128 v6, v[68:71] offset:2048
    ds_write_b128 v6, v[72:75] offset:3072
    ds_write_b128 v6, v[76:79] offset:4096
    ds_write_b128 v6, v[80:83] offset:5120
    ds_write_b128 v6, v[84:87] offset:6144
    ds_write_b128 v6, v[88:91] offset:7168
    ds_read_b64_tr_b16 v[92:93], v16 offset:0
    ds_read_b64_tr_b16 v[94:95], v16 offset:128
    ds_read_b128 v[96:99], v17 offset:512
    ds_read_b64_tr_b16 v[100:101], v16 offset:1024
    ds_read_b64_tr_b16 v[102:103], v16 offset:1152
    ds_read_b128 v[104:107], v17 offset:576
    ds_read_b64_tr_b16 v[108:109], v16 offset:2048
    ds_read_b64_tr_b16 v[110:111], v16 offset:2176
    ds_read_b128 v[112:115], v17 offset:640
    ds_read_b64_tr_b16 v[116:117], v16 offset:3072
    ds_read_b64_tr_b16 v[118:119], v16 offset:3200
    ds_read_b128 v[120:123], v17 offset:704
    s_waitcnt lgkmcnt(9)
    v_mfma_f32_16x16x32_bf16 v[20:23], v[92:95], v[96:99], v[20:23]
    s_waitcnt lgkmcnt(6)
    v_mfma_f32_16x16x32_bf16 v[20:23], v[100:103], v[104:107], v[20:23]
    s_waitcnt lgkmcnt(3)
    v_mfma_f32_16x16x32_bf16 v[20:23], v[108:111], v[112:115], v[20:23]
    s_waitcnt lgkmcnt(0)
    v_mfma_f32_16x16x32_bf16 v[20:23], v[116:119], v[120:123], v[20:23]
    ds_read_b64_tr_b16 v[92:93], v16 offset:4096
    ds_read_b64_tr_b16 v[94:95], v16 offset:4224
    ds_read_b128 v[96:99], v17 offset:768
    ds_read_b64_tr_b16 v[100:101], v16 offset:5120
    ds_read_b64_tr_b16 v[102:103], v16 offset:5248
    ds_read_b128 v[104:107], v17 offset:832
    ds_read_b64_tr_b16 v[108:109], v16 offset:6144
    ds_read_b64_tr_b16 v[110:111], v16 offset:6272
    ds_read_b128 v[112:115], v17 offset:896
    ds_read_b64_tr_b16 v[116:117], v16 offset:7168
    ds_read_b64_tr_b16 v[118:119], v16 offset:7296
    ds_read_b128 v[120:123], v17 offset:960
    s_waitcnt lgkmcnt(9)
    v_mfma_f32_16x16x32_bf16 v[20:23], v[92:95], v[96:99], v[20:23]
    s_waitcnt lgkmcnt(6)
    v_mfma_f32_16x16x32_bf16 v[20:23], v[100:103], v[104:107], v[20:23]
    s_waitcnt lgkmcnt(3)
    v_mfma_f32_16x16x32_bf16 v[20:23], v[108:111], v[112:115], v[20:23]
    s_waitcnt lgkmcnt(0)
    v_mfma_f32_16x16x32_bf16 v[20:23], v[116:119], v[120:123], v[20:23]
    s_nop 7
    v_cvt_pk_bf16_f32 v20, v20, v21
    v_cvt_pk_bf16_f32 v21, v22, v23
    v_readlane_b32 s64, v20, 0
    v_readlane_b32 s65, v21, 0
    s_atomic_swap_x2 s[64:65], s[8:9], s60 offset:0 glc
    v_readlane_b32 s66, v20, 16
    v_readlane_b32 s67, v21, 16
    s_atomic_swap_x2 s[66:67], s[8:9], s60 offset:8 glc
    v_readlane_b32 s68, v20, 32
    v_readlane_b32 s69, v21, 32
    s_atomic_swap_x2 s[68:69], s[8:9], s60 offset:16 glc
    v_readlane_b32 s70, v20, 48
    v_readlane_b32 s71, v21, 48
    s_atomic_swap_x2 s[70:71], s[8:9], s60 offset:24 glc
    v_readlane_b32 s72, v20, 1
    v_readlane_b32 s73, v21, 1
    s_atomic_swap_x2 s[72:73], s[8:9], s60 offset:8192 glc
    v_readlane_b32 s74, v20, 17
    v_readlane_b32 s75, v21, 17
    s_atomic_swap_x2 s[74:75], s[8:9], s60 offset:8200 glc
    v_readlane_b32 s76, v20, 33
    v_readlane_b32 s77, v21, 33
    s_atomic_swap_x2 s[76:77], s[8:9], s60 offset:8208 glc
    v_readlane_b32 s78, v20, 49
    v_readlane_b32 s79, v21, 49
    s_atomic_swap_x2 s[78:79], s[8:9], s60 offset:8216 glc
    v_readlane_b32 s80, v20, 2
    v_readlane_b32 s81, v21, 2
    s_atomic_swap_x2 s[80:81], s[8:9], s60 offset:16384 glc
    v_readlane_b32 s82, v20, 18
    v_readlane_b32 s83, v21, 18
    s_atomic_swap_x2 s[82:83], s[8:9], s60 offset:16392 glc
    v_readlane_b32 s84, v20, 34
    v_readlane_b32 s85, v21, 34
    s_atomic_swap_x2 s[84:85], s[8:9], s60 offset:16400 glc
    v_readlane_b32 s86, v20, 50
    v_readlane_b32 s87, v21, 50
    s_atomic_swap_x2 s[86:87], s[8:9], s60 offset:16408 glc
    v_readlane_b32 s88, v20, 3
    v_readlane_b32 s89, v21, 3
    s_atomic_swap_x2 s[88:89], s[8:9], s60 offset:24576 glc
    v_readlane_b32 s90, v20, 19
    v_readlane_b32 s91, v21, 19
    s_atomic_swap_x2 s[90:91], s[8:9], s60 offset:24584 glc
    v_readlane_b32 s92, v20, 35
    v_readlane_b32 s93, v21, 35
    s_atomic_swap_x2 s[92:93], s[8:9], s60 offset:24592 glc
    v_readlane_b32 s94, v20, 51
    v_readlane_b32 s95, v21, 51
    s_atomic_swap_x2 s[94:95], s[8:9], s60 offset:24600 glc
    s_mov_b32 s62, 1
    s_waitcnt vmcnt(0) lgkmcnt(0)
    s_atomic_add s62, s[4:5], s61 glc
    s_waitcnt lgkmcnt(0)
    s_mov_b32 s61, s62
    s_cmp_lg_u32 s62, 31
    s_cbranch_scc1 L_notlast
    s_lshl_b32 s56, s10, 7
    s_add_u32 s56, s56, 32768
    s_mov_b32 s62, 2
    s_atomic_add s62, s[8:9], s56 offset:0
    s_atomic_add s62, s[8:9], s56 offset:1024
    s_atomic_add s62, s[8:9], s56 offset:2048
    s_atomic_add s62, s[8:9], s56 offset:3072
    s_atomic_add s62, s[8:9], s56 offset:4096
    s_atomic_add s62, s[8:9], s56 offset:5120
    s_atomic_add s62, s[8:9], s56 offset:6144
    s_atomic_add s62, s[8:9], s56 offset:7168
    s_atomic_add s62, s[8:9], s56 offset:8192
    s_atomic_add s62, s[8:9], s56 offset:9216
    s_atomic_add s62, s[8:9], s56 offset:10240
    s_atomic_add s62, s[8:9], s56 offset:11264
    s_atomic_add s62, s[8:9], s56 offset:12288
    s_atomic_add s62, s[8:9], s56 offset:13312
    s_atomic_add s62, s[8:9], s56 offset:14336
    s_atomic_add s62, s[8:9], s56 offset:15360
    s_atomic_add s62, s[8:9], s56 offset:16384
    s_atomic_add s62, s[8:9], s56 offset:17408
    s_atomic_add s62, s[8:9], s56 offset:18432
    s_atomic_add s62, s[8:9], s56 offset:19456
    s_atomic_add s62, s[8:9], s56 offset:20480
    s_atomic_add s62, s[8:9], s56 offset:21504
    s_atomic_add s62, s[8:9], s56 offset:22528
    s_atomic_add s62, s[8:9], s56 offset:23552
    s_atomic_add s62, s[8:9], s56 offset:24576
    s_atomic_add s62, s[8:9], s56 offset:25600
    s_atomic_add s62, s[8:9], s56 offset:26624
    s_atomic_add s62, s[8:9], s56 offset:27648
    s_atomic_add s62, s[8:9], s56 offset:28672
    s_atomic_add s62, s[8:9], s56 offset:29696
    s_atomic_add s62, s[8:9], s56 offset:30720
    s_atomic_add s62, s[8:9], s56 offset:31744
L_notlast:
    s_nop 7
    s_nop 3
    s_lshl_b32 s63, s2, 7
    s_add_u32 s63, s63, 32768
    s_mov_b32 s62, 0
L_qpoll:
    s_nop 7
    s_nop 3
    s_load_dword s56, s[8:9], s63 glc
    s_waitcnt lgkmcnt(0)
    s_cmp_eq_u32 s56, 1
    s_cbranch_scc1 L_qgot
    s_sleep 1
    s_add_u32 s62, s62, 1
    s_cmp_lt_u32 s62, 65536
    s_cbranch_scc1 L_qpoll
L_qgot:
    s_nop 7
    s_nop 3
    v_mov_b32 v10, 1
    s_mov_b64 exec, 1
    ds_add_u32 v9, v10 offset:15820
    s_mov_b64 exec, -1
    s_branch L_qf
L_qwait:
    s_nop 7
    s_nop 3
    s_mov_b32 s62, 0
L_lwq:
    s_nop 7
    s_nop 3
    ds_read_b32 v10, v9 offset:15820
    s_waitcnt lgkmcnt(0)
    v_readfirstlane_b32 s56, v10
    s_nop 0
    s_cmp_eq_u32 s56, 1
    s_cbranch_scc1 L_lwdq
    s_sleep 1
    s_add_u32 s62, s62, 1
    s_cmp_lt_u32 s62, 1048576
    s_cbranch_scc1 L_lwq
L_lwdq:
    s_nop 7
    s_nop 3
L_qf:
    s_nop 7
    s_nop 3
    s_lshl_b32 s56, s12, 13
    s_lshl_b32 s57, s10, 10
    s_add_u32 s56, s56, s57
    s_lshl_b32 s57, s3, 7
    s_add_u32 s56, s56, s57
    s_add_u32 s57, s56, 64
    s_load_dwordx16 s[64:79], s[8:9], s56 glc
    s_load_dwordx16 s[80:95], s[8:9], s57 glc
    s_lshl_b32 s56, s3, 7
    s_add_u32 s56, s56, 14464
    v_lshlrev_b32 v4, 2, v1
    v_add_u32 v4, s56, v4
    s_waitcnt lgkmcnt(0)
    v_writelane_b32 v5, s64, 0
    v_writelane_b32 v5, s65, 1
    v_writelane_b32 v5, s66, 2
    v_writelane_b32 v5, s67, 3
    v_writelane_b32 v5, s68, 4
    v_writelane_b32 v5, s69, 5
    v_writelane_b32 v5, s70, 6
    v_writelane_b32 v5, s71, 7
    v_writelane_b32 v5, s72, 8
    v_writelane_b32 v5, s73, 9
    v_writelane_b32 v5, s74, 10
    v_writelane_b32 v5, s75, 11
    v_writelane_b32 v5, s76, 12
    v_writelane_b32 v5, s77, 13
    v_writelane_b32 v5, s78, 14
    v_writelane_b32 v5, s79, 15
    v_writelane_b32 v5, s80, 16
    v_writelane_b32 v5, s81, 17
    v_writelane_b32 v5, s82, 18
    v_writelane_b32 v5, s83, 19
    v_writelane_b32 v5, s84, 20
    v_writelane_b32 v5, s85, 21
    v_writelane_b32 v5, s86, 22
    v_writelane_b32 v5, s87, 23
    v_writelane_b32 v5, s88, 24
    v_writelane_b32 v5, s89, 25
    v_writelane_b32 v5, s90, 26
    v_writelane_b32 v5, s91, 27
    v_writelane_b32 v5, s92, 28
    v_writelane_b32 v5, s93, 29
    v_writelane_b32 v5, s94, 30
    v_writelane_b32 v5, s95, 31
    s_mov_b32 exec_lo, -1
    s_mov_b32 exec_hi, 0
    ds_write_b32 v4, v5
    s_mov_b64 exec, -1
    v_mov_b32 v10, 1
    s_mov_b64 exec, 1
    ds_add_u32 v9, v10 offset:15824
    s_mov_b64 exec, -1
    s_cmp_ge_u32 s3, 4
    s_cbranch_scc1 L_cons
    s_cmp_eq_u32 s3, 3
    s_cbranch_scc1 L_wts
    s_cmp_lg_u32 s3, 0
    s_cbranch_scc1 L_epi
    s_cmp_lg_u32 s61, 31
    s_cbranch_scc1 L_notlast2
    s_mov_b32 s62, 1
    s_atomic_add s62, s[4:5], 240 glc
    s_waitcnt lgkmcnt(0)
    s_cmp_lg_u32 s62, 7
    s_cbranch_scc1 L_notlast2
    s_mov_b32 s62, 2
    s_mov_b32 s56, 49156
L_allc:
    s_nop 7
    s_nop 3
    s_atomic_add s62, s[8:9], s56 offset:0
    s_atomic_add s62, s[8:9], s56 offset:128
    s_atomic_add s62, s[8:9], s56 offset:256
    s_atomic_add s62, s[8:9], s56 offset:384
    s_atomic_add s62, s[8:9], s56 offset:512
    s_atomic_add s62, s[8:9], s56 offset:640
    s_atomic_add s62, s[8:9], s56 offset:768
    s_atomic_add s62, s[8:9], s56 offset:896
    s_add_u32 s56, s56, 1024
    s_cmp_lt_u32 s56, 65536
    s_cbranch_scc1 L_allc
L_notlast2:
    s_nop 7
    s_nop 3
    s_cmp_lt_u32 s11, 16
    s_cbranch_scc1 L_epi0
    s_mov_b32 s62, 0
    s_lshl_b32 s63, s2, 7
    s_add_u32 s63, s63, 32772
L_cnt:
    s_nop 7
    s_nop 3
    s_load_dword s56, s[8:9], s63 glc
    s_waitcnt lgkmcnt(0)
    s_cmp_eq_u32 s56, 1
    s_cbranch_scc1 L_epi0
L_cnt_retry:
    s_nop 7
    s_nop 3
    s_sleep 32
    s_add_u32 s62, s62, 1
    s_cmp_lt_u32 s62, 65536
    s_cbranch_scc1 L_cnt
    s_branch L_epi0
L_wts:
    s_nop 7
    s_nop 3
    s_cmp_ge_u32 s11, 30
    s_cbranch_scc1 L_epi
    s_mov_b32 s62, 0
L_wtp:
    s_nop 7
    s_nop 3
    ds_read_b32 v10, v9 offset:15808
    s_waitcnt lgkmcnt(0)
    v_readfirstlane_b32 s56, v10
    s_nop 0
    s_mov_b32 s66, s56
    s_cmp_ge_u32 s56, 63
    s_cbranch_scc1 L_wtg
    s_sleep 2
    s_add_u32 s62, s62, 1
    s_cmp_lt_u32 s62, 1048576
    s_cbranch_scc1 L_wtp
L_wtg:
    s_nop 7
    s_nop 3
    s_cmp_ge_u32 s11, 16
    s_cbranch_scc1 L_wf
    v_lshrrev_b32 v4, 2, v1
    v_lshlrev_b32 v4, 10, v4
    v_and_b32 v5, 3, v1
    v_lshl_add_u32 v4, v5, 4, v4
    s_lshl_b32 s60, s10, 19
    s_lshl_b32 s57, s11, 6
    s_add_u32 s60, s60, s57
    s_mov_b32 s62, 0
L_lwwo0:
    s_nop 7
    s_nop 3
    ds_read_b32 v10, v9 offset:15844
    s_waitcnt lgkmcnt(0)
    v_readfirstlane_b32 s56, v10
    s_nop 0
    s_cmp_eq_u32 s56, 56
    s_cbranch_scc1 L_lwdwo0
    s_sleep 1
    s_add_u32 s62, s62, 1
    s_cmp_lt_u32 s62, 1048576
    s_cbranch_scc1 L_lwwo0
L_lwdwo0:
    s_nop 7
    s_nop 3
    s_mov_b32 s57, 32768
LN_wo0:
    s_mov_b32 m0, s57
    s_nop 0
    buffer_load_dwordx4 v4, s[32:35], s60 offen nt lds
    s_add_u32 s60, s60, 16384
    s_add_u32 s57, s57, 1024
    s_mov_b32 m0, s57
    s_nop 0
    buffer_load_dwordx4 v4, s[32:35], s60 offen nt lds
    s_add_u32 s60, s60, 16384
    s_add_u32 s57, s57, 1024
    s_mov_b32 m0, s57
    s_nop 0
    buffer_load_dwordx4 v4, s[32:35], s60 offen nt lds
    s_add_u32 s60, s60, 16384
    s_add_u32 s57, s57, 1024
    s_mov_b32 m0, s57
    s_nop 0
    buffer_load_dwordx4 v4, s[32:35], s60 offen nt lds
    s_add_u32 s60, s60, 16384
    s_add_u32 s57, s57, 1024
    s_cmp_lt_u32 s57, 49152
    s_cbranch_scc1 LN_wo0
    s_mov_b32 s62, 0
L_lwwo1:
    s_nop 7
    s_nop 3
    ds_read_b32 v10, v9 offset:15848
    s_waitcnt lgkmcnt(0)
    v_readfirstlane_b32 s56, v10
    s_nop 0
    s_cmp_eq_u32 s56, 57
    s_cbranch_scc1 L_lwdwo1
    s_sleep 1
    s_add_u32 s62, s62, 1
    s_cmp_lt_u32 s62, 1048576
    s_cbranch_scc1 L_lwwo1
L_lwdwo1:
    s_nop 7
    s_nop 3
    s_mov_b32 s57, 49152
LN_wo1:
    s_mov_b32 m0, s57
    s_nop 0
    buffer_load_dwordx4 v4, s[32:35], s60 offen nt lds
    s_add_u32 s60, s60, 16384
    s_add_u32 s57, s57, 1024
    s_mov_b32 m0, s57
    s_nop 0
    buffer_load_dwordx4 v4, s[32:35], s60 offen nt lds
    s_add_u32 s60, s60, 16384
    s_add_u32 s57, s57, 1024
    s_mov_b32 m0, s57
    s_nop 0
    buffer_load_dwordx4 v4, s[32:35], s60 offen nt lds
    s_add_u32 s60, s60, 16384
    s_add_u32 s57, s57, 1024
    s_mov_b32 m0, s57
    s_nop 0
    buffer_load_dwordx4 v4, s[32:35], s60 offen nt lds
    s_add_u32 s60, s60, 16384
    s_add_u32 s57, s57, 1024
    s_cmp_lt_u32 s57, 65536
    s_cbranch_scc1 LN_wo1
    s_branch L_epi1
L_wf:
    s_nop 7
    s_nop 3
    s_mov_b32 s62, 0
L_lwpf:
    s_nop 7
    s_nop 3
    ds_read_b32 v10, v9 offset:15836
    s_waitcnt lgkmcnt(0)
    v_readfirstlane_b32 s56, v10
    s_nop 0
    s_cmp_eq_u32 s56, 2
    s_cbranch_scc1 L_lwdpf
    s_sleep 1
    s_add_u32 s62, s62, 1
    s_cmp_lt_u32 s62, 1048576
    s_cbranch_scc1 L_lwpf
L_lwdpf:
    s_nop 7
    s_nop 3
    v_lshrrev_b32 v4, 1, v1
    s_movk_i32 s56, 3584
    v_mul_lo_u32 v4, v4, s56
    v_and_b32 v5, 1, v1
    v_lshl_add_u32 v4, v5, 4, v4
    v_lshlrev_b32 v6, 4, v1
    s_mov_b32 s62, 0
L_lwwf0:
    s_nop 7
    s_nop 3
    ds_read_b32 v10, v9 offset:15844
    s_waitcnt lgkmcnt(0)
    v_readfirstlane_b32 s56, v10
    s_nop 0
    s_cmp_eq_u32 s56, 56
    s_cbranch_scc1 L_lwdwf0
    s_sleep 1
    s_add_u32 s62, s62, 1
    s_cmp_lt_u32 s62, 1048576
    s_cbranch_scc1 L_lwwf0
L_lwdwf0:
    s_nop 7
    s_nop 3
    s_lshl_b32 s60, s15, 5
    s_mov_b32 s57, 32768
LN_wf0:
    s_mov_b32 m0, s57
    s_nop 0
    buffer_load_dwordx4 v4, s[32:35], s60 offen nt lds
    s_add_u32 s60, s60, 114688
    s_add_u32 s57, s57, 1024
    s_mov_b32 m0, s57
    s_nop 0
    buffer_load_dwordx4 v4, s[32:35], s60 offen nt lds
    s_add_u32 s60, s60, 114688
    s_add_u32 s57, s57, 1024
    s_mov_b32 m0, s57
    s_nop 0
    buffer_load_dwordx4 v4, s[32:35], s60 offen nt lds
    s_add_u32 s60, s60, 114688
    s_add_u32 s57, s57, 1024
    s_mov_b32 m0, s57
    s_nop 0
    buffer_load_dwordx4 v4, s[32:35], s60 offen nt lds
    s_add_u32 s60, s60, 114688
    s_add_u32 s57, s57, 1024
    s_cmp_lt_u32 s57, 49152
    s_cbranch_scc1 LN_wf0
    s_mov_b32 s62, 0
L_lwwf1:
    s_nop 7
    s_nop 3
    ds_read_b32 v10, v9 offset:15848
    s_waitcnt lgkmcnt(0)
    v_readfirstlane_b32 s56, v10
    s_nop 0
    s_cmp_eq_u32 s56, 57
    s_cbranch_scc1 L_lwdwf1
    s_sleep 1
    s_add_u32 s62, s62, 1
    s_cmp_lt_u32 s62, 1048576
    s_cbranch_scc1 L_lwwf1
L_lwdwf1:
    s_nop 7
    s_nop 3
    s_lshl_b32 s60, s15, 5
    s_mov_b32 s57, 49152
LN_wf1:
    s_mov_b32 m0, s57
    s_nop 0
    buffer_load_dwordx4 v4, s[36:39], s60 offen nt lds
    s_add_u32 s60, s60, 114688
    s_add_u32 s57, s57, 1024
    s_mov_b32 m0, s57
    s_nop 0
    buffer_load_dwordx4 v4, s[36:39], s60 offen nt lds
    s_add_u32 s60, s60, 114688
    s_add_u32 s57, s57, 1024
    s_mov_b32 m0, s57
    s_nop 0
    buffer_load_dwordx4 v4, s[36:39], s60 offen nt lds
    s_add_u32 s60, s60, 114688
    s_add_u32 s57, s57, 1024
    s_mov_b32 m0, s57
    s_nop 0
    buffer_load_dwordx4 v4, s[36:39], s60 offen nt lds
    s_add_u32 s60, s60, 114688
    s_add_u32 s57, s57, 1024
    s_cmp_lt_u32 s57, 65536
    s_cbranch_scc1 LN_wf1
    s_mov_b32 s62, 0
L_lwwf2:
    s_nop 7
    s_nop 3
    ds_read_b32 v10, v9 offset:15852
    s_waitcnt lgkmcnt(0)
    v_readfirstlane_b32 s56, v10
    s_nop 0
    s_cmp_eq_u32 s56, 58
    s_cbranch_scc1 L_lwdwf2
    s_sleep 1
    s_add_u32 s62, s62, 1
    s_cmp_lt_u32 s62, 1048576
    s_cbranch_scc1 L_lwwf2
L_lwdwf2:
    s_nop 7
    s_nop 3
    s_lshl_b32 s60, s15, 14
    s_mov_b32 s57, 65536
LN_wf2:
    s_mov_b32 m0, s57
    s_nop 0
    buffer_load_dwordx4 v6, s[40:43], s60 offen nt lds
    s_add_u32 s60, s60, 1024
    s_add_u32 s57, s57, 1024
    s_mov_b32 m0, s57
    s_nop 0
    buffer_load_dwordx4 v6, s[40:43], s60 offen nt lds
    s_add_u32 s60, s60, 1024
    s_add_u32 s57, s57, 1024
    s_mov_b32 m0, s57
    s_nop 0
    buffer_load_dwordx4 v6, s[40:43], s60 offen nt lds
    s_add_u32 s60, s60, 1024
    s_add_u32 s57, s57, 1024
    s_mov_b32 m0, s57
    s_nop 0
    buffer_load_dwordx4 v6, s[40:43], s60 offen nt lds
    s_add_u32 s60, s60, 1024
    s_add_u32 s57, s57, 1024
    s_cmp_lt_u32 s57, 81920
    s_cbranch_scc1 LN_wf2
    s_branch L_epi1
L_loader:
    s_nop 7
    s_nop 3
    s_setprio 3
    v_xor_b32 v7, v2, v3
    v_lshlrev_b32 v5, 8, v3
    v_lshl_add_u32 v152, v7, 4, v5
    v_xor_b32 v153, 0x40, v152
    v_xor_b32 v154, 0x80, v152
    v_xor_b32 v155, 0xc0, v152
    v_lshlrev_b32 v4, 1, v3
    v_xor_b32 v4, v2, v4
    v_lshl_add_u32 v156, v4, 4, v5
    v_xor_b32 v157, 0x80, v156
    s_lshr_b32 s70, s14, 3
    s_mul_i32 s70, s70, 16
    s_lshl_b32 s65, s13, 6
    s_mov_b32 s64, 0
    s_mov_b32 s71, 16384
    s_mov_b32 s72, 0
    s_mov_b32 s73, 0
    s_mov_b32 s69, 0
    s_mov_b32 s74, 0
    v_mov_b32 v20, 0
    v_mov_b32 v11, s73
    ds_read_b32 v14, v11 offset:15840
LN_ld:
    s_sub_u32 s67, s64, 8
    s_waitcnt lgkmcnt(0)
    v_readfirstlane_b32 s56, v14
    s_cmp_ge_u32 s64, 64
    s_cbranch_scc1 L_ldend
    s_cmp_eq_u32 s56, s67
    s_cbranch_scc1 LN_fg
LN_fr:
    s_sleep 1
    v_mov_b32 v11, s73
    ds_read_b32 v14, v11 offset:15840
    s_add_u32 s69, s69, 1
    s_cmp_lt_u32 s69, 1048576
    s_cbranch_scc1 LN_ld
    s_branch L_ldend
LN_fg:
    s_lshl_b32 s56, s65, 13
    s_add_u32 s57, s56, 4096
    s_waitcnt vmcnt(18)
    s_add_u32 m0, s71, 0
    s_nop 0
    buffer_load_dwordx4 v152, s[16:19], s56 offen offset:0 nt lds
    buffer_load_dwordx4 v152, s[16:19], s56 offen offset:1024 nt lds
    buffer_load_dwordx4 v153, s[16:19], s56 offen offset:2048 nt lds
    buffer_load_dwordx4 v153, s[16:19], s56 offen offset:3072 nt lds
    s_add_u32 m0, s71, 4096
    s_nop 0
    buffer_load_dwordx4 v154, s[16:19], s57 offen offset:0 nt lds
    buffer_load_dwordx4 v154, s[16:19], s57 offen offset:1024 nt lds
    buffer_load_dwordx4 v155, s[16:19], s57 offen offset:2048 nt lds
    buffer_load_dwordx4 v155, s[16:19], s57 offen offset:3072 nt lds
    s_waitcnt vmcnt(18)
    s_add_u32 m0, s71, 8192
    s_nop 0
    buffer_load_dwordx4 v156, s[20:23], s56 offen offset:0 nt lds
    buffer_load_dwordx4 v156, s[20:23], s56 offen offset:1024 nt lds
    buffer_load_dwordx4 v157, s[20:23], s56 offen offset:2048 nt lds
    buffer_load_dwordx4 v157, s[20:23], s56 offen offset:3072 nt lds
    s_add_u32 m0, s71, 12288
    s_nop 0
    buffer_load_dwordx4 v156, s[20:23], s57 offen offset:0 nt lds
    buffer_load_dwordx4 v156, s[20:23], s57 offen offset:1024 nt lds
    buffer_load_dwordx4 v157, s[20:23], s57 offen offset:2048 nt lds
    buffer_load_dwordx4 v157, s[20:23], s57 offen offset:3072 nt lds
    s_add_u32 s65, s65, 1
    s_add_u32 s71, s71, 16384
    s_add_u32 s73, s73, 4
    s_cmp_eq_u32 s73, 36
    s_cselect_b32 s73, 0, s73
    s_cselect_b32 s71, 16384, s71
    s_cmp_lt_u32 s64, 2
    s_cbranch_scc1 LN_np
    s_sub_u32 s67, s64, 1
    v_mov_b32 v10, s67
    v_mov_b32 v13, s72
    s_mov_b64 exec, 1
    ds_write_b32 v13, v10 offset:15744
    s_mov_b64 exec, -1
    s_add_u32 s72, s72, 8
    s_cmp_eq_u32 s72, 72
    s_cselect_b32 s72, 0, s72
LN_np:
    s_add_u32 s64, s64, 1
    v_mov_b32 v11, s73
    ds_read_b32 v14, v11 offset:15840
    s_branch LN_ld
L_ldend:
    s_nop 7
    s_nop 3
    v_lshlrev_b32 v11, 3, v1
    v_mov_b32 v10, s64
    s_mov_b64 exec, 511
    ds_write_b32 v11, v10 offset:15748
    s_mov_b64 exec, -1
    s_sub_u32 s67, s64, 1
    s_waitcnt vmcnt(16)
    v_mov_b32 v10, s67
    v_mov_b32 v13, s72
    s_mov_b64 exec, 1
    ds_write_b32 v13, v10 offset:15744
    s_mov_b64 exec, -1
    s_add_u32 s72, s72, 8
    s_cmp_eq_u32 s72, 72
    s_cselect_b32 s72, 0, s72
    s_sub_u32 s67, s64, 0
    s_waitcnt vmcnt(0)
    v_mov_b32 v10, s67
    v_mov_b32 v13, s72
    s_mov_b64 exec, 1
    ds_write_b32 v13, v10 offset:15744
    s_mov_b64 exec, -1
    s_add_u32 s72, s72, 8
    s_cmp_eq_u32 s72, 72
    s_cselect_b32 s72, 0, s72
    s_waitcnt lgkmcnt(0)
    s_endpgm
L_cons:
    s_nop 7
    s_nop 3
    v_and_b32 v7, 3, v2
    v_lshlrev_b32 v7, 8, v7
    v_lshl_add_u32 v7, v3, 4, v7
    s_mov_b32 s62, 0
L_lwc:
    s_nop 7
    s_nop 3
    ds_read_b32 v10, v9 offset:15824
    s_waitcnt lgkmcnt(0)
    v_readfirstlane_b32 s56, v10
    s_nop 0
    s_cmp_eq_u32 s56, 8
    s_cbranch_scc1 L_lwdc
    s_sleep 1
    s_add_u32 s62, s62, 1
    s_cmp_lt_u32 s62, 1048576
    s_cbranch_scc1 L_lwc
L_lwdc:
    s_nop 7
    s_nop 3
    ds_read_b128 v[8:11], v7 offset:14464
    ds_read_b128 v[12:15], v7 offset:14528
    ds_read_b128 v[16:19], v7 offset:14592
    ds_read_b128 v[20:23], v7 offset:14656
    s_mov_b32 s96, s6
    s_mov_b32 s64, s6
L_poll:
    s_nop 7
    s_nop 3
    s_lshl_b32 s56, s64, 3
    v_mov_b32 v160, s56
    s_add_u32 s65, s96, 1
    s_mov_b32 s62, 0
L_poll1:
    s_nop 7
    s_nop 3
    ds_read_b64 v[158:159], v160 offset:15744
    s_waitcnt lgkmcnt(0)
    v_readfirstlane_b32 s56, v158
    v_readfirstlane_b32 s67, v159
    s_cmp_eq_u32 s56, s65
    s_cbranch_scc1 L_go
    s_cmp_ge_u32 s96, s67
    s_cbranch_scc1 L_cdone
    s_sleep 1
    s_add_u32 s62, s62, 1
    s_cmp_lt_u32 s62, 1048576
    s_cbranch_scc1 L_poll1
    s_branch L_cdone
L_go:
    s_nop 7
    s_nop 3
    ds_read_b128 v[68:71], v132 offset:0
    ds_read_b128 v[72:75], v133 offset:0
    ds_read_b128 v[76:79], v134 offset:0
    ds_read_b128 v[80:83], v135 offset:0
    ds_read_b128 v[84:87], v132 offset:1024
    ds_read_b128 v[88:91], v133 offset:1024
    ds_read_b128 v[92:95], v134 offset:1024
    ds_read_b128 v[96:99], v135 offset:1024
    ds_read_b64_tr_b16 v[100:101], v136 offset:8192
    ds_read_b64_tr_b16 v[102:103], v136 offset:9216
    ds_read_b64_tr_b16 v[104:105], v137 offset:8192
    ds_read_b64_tr_b16 v[106:107], v137 offset:9216
    ds_read_b64_tr_b16 v[108:109], v138 offset:8192
    ds_read_b64_tr_b16 v[110:111], v138 offset:9216
    s_waitcnt lgkmcnt(10)
    v_mfma_f32_16x16x32_bf16 v[56:59], v[68:71], v[8:11], 0
    v_mfma_f32_16x16x32_bf16 v[56:59], v[72:75], v[12:15], v[56:59]
    v_mfma_f32_16x16x32_bf16 v[56:59], v[76:79], v[16:19], v[56:59]
    v_mfma_f32_16x16x32_bf16 v[56:59], v[80:83], v[20:23], v[56:59]
    s_waitcnt lgkmcnt(6)
    v_mfma_f32_16x16x32_bf16 v[60:63], v[84:87], v[8:11], 0
    v_mfma_f32_16x16x32_bf16 v[60:63], v[88:91], v[12:15], v[60:63]
    v_mfma_f32_16x16x32_bf16 v[60:63], v[92:95], v[16:19], v[60:63]
    v_mfma_f32_16x16x32_bf16 v[60:63], v[96:99], v[20:23], v[60:63]
    ds_read_b64_tr_b16 v[112:113], v139 offset:8192
    ds_read_b64_tr_b16 v[114:115], v139 offset:9216
    ds_read_b64_tr_b16 v[116:117], v140 offset:8192
    ds_read_b64_tr_b16 v[118:119], v140 offset:9216
    ds_read_b64_tr_b16 v[120:121], v141 offset:8192
    ds_read_b64_tr_b16 v[122:123], v141 offset:9216
    ds_read_b64_tr_b16 v[124:125], v142 offset:8192
    ds_read_b64_tr_b16 v[126:127], v142 offset:9216
    s_waitcnt lgkmcnt(8)
    ds_read_b64_tr_b16 v[128:129], v143 offset:8192
    ds_read_b64_tr_b16 v[130:131], v143 offset:9216
    s_lshl_b32 s56, s64, 2
    v_mov_b32 v160, s56
    s_add_u32 s65, s96, 1
    v_mov_b32 v161, s65
    s_add_u32 s64, s64, 4
    s_mov_b32 s66, 65536
    s_cmp_ge_u32 s64, 9
    s_cselect_b32 s66, -81920, s66
    s_cselect_b32 s57, 9, 0
    s_sub_u32 s64, s64, s57
    v_cvt_pk_bf16_f32 v158, v56, v57
    v_lshlrev_b32 v56, 16, v158
    v_and_b32 v57, 0xffff0000, v158
    v_mul_f32 v56, s98, v56
    v_mul_f32 v57, s98, v57
    v_cvt_pk_bf16_f32 v158, v56, v57
    v_lshlrev_b32 v56, 16, v158
    v_and_b32 v57, 0xffff0000, v158
    v_max3_f32 v145, v56, v57, v144
    v_cvt_pk_bf16_f32 v158, v58, v59
    v_lshlrev_b32 v58, 16, v158
    v_and_b32 v59, 0xffff0000, v158
    v_mul_f32 v58, s98, v58
    v_mul_f32 v59, s98, v59
    v_cvt_pk_bf16_f32 v158, v58, v59
    v_lshlrev_b32 v58, 16, v158
    v_and_b32 v59, 0xffff0000, v158
    v_max3_f32 v145, v58, v59, v145
    v_cvt_pk_bf16_f32 v158, v60, v61
    v_lshlrev_b32 v60, 16, v158
    v_and_b32 v61, 0xffff0000, v158
    v_mul_f32 v60, s98, v60
    v_mul_f32 v61, s98, v61
    v_cvt_pk_bf16_f32 v158, v60, v61
    v_lshlrev_b32 v60, 16, v158
    v_and_b32 v61, 0xffff0000, v158
    v_max3_f32 v145, v60, v61, v145
    v_cvt_pk_bf16_f32 v158, v62, v63
    v_lshlrev_b32 v62, 16, v158
    v_and_b32 v63, 0xffff0000, v158
    v_mul_f32 v62, s98, v62
    v_mul_f32 v63, s98, v63
    v_cvt_pk_bf16_f32 v158, v62, v63
    v_lshlrev_b32 v62, 16, v158
    v_and_b32 v63, 0xffff0000, v158
    v_max3_f32 v145, v62, v63, v145
    v_mov_b32 v147, v145
    s_nop 1
    v_permlane16_swap_b32 v145, v147
    v_max_f32 v145, v145, v147
    v_mov_b32 v147, v145
    s_nop 1
    v_permlane32_swap_b32 v145, v147
    v_max_f32 v145, v145, v147
    s_waitcnt lgkmcnt(0)
    s_mov_b64 exec, 1
    ds_write_b32 v160, v161 offset:15840
    s_mov_b64 exec, -1
    v_add_u32 v132, s66, v132
    v_add_u32 v133, s66, v133
    v_add_u32 v134, s66, v134
    v_add_u32 v135, s66, v135
    v_add_u32 v136, s66, v136
    v_add_u32 v137, s66, v137
    v_add_u32 v138, s66, v138
    v_add_u32 v139, s66, v139
    v_add_u32 v140, s66, v140
    v_add_u32 v141, s66, v141
    v_add_u32 v142, s66, v142
    v_add_u32 v143, s66, v143
    v_cmp_lt_f32 vcc, v144, v145
    s_nop 0
    s_cmp_eq_u64 vcc, 0
    s_cbranch_scc1 L_nores
    v_sub_f32 v147, v144, v145
    v_mul_f32 v147, s99, v147
    v_exp_f32 v147, v147
    v_mov_b32 v144, v145
    v_mul_f32 v148, s99, v145
    v_mul_f32 v146, v147, v146
    v_mul_f32 v24, v147, v24
    v_mul_f32 v25, v147, v25
    v_mul_f32 v26, v147, v26
    v_mul_f32 v27, v147, v27
    v_mul_f32 v28, v147, v28
    v_mul_f32 v29, v147, v29
    v_mul_f32 v30, v147, v30
    v_mul_f32 v31, v147, v31
    v_mul_f32 v32, v147, v32
    v_mul_f32 v33, v147, v33
    v_mul_f32 v34, v147, v34
    v_mul_f32 v35, v147, v35
    v_mul_f32 v36, v147, v36
    v_mul_f32 v37, v147, v37
    v_mul_f32 v38, v147, v38
    v_mul_f32 v39, v147, v39
    v_mul_f32 v40, v147, v40
    v_mul_f32 v41, v147, v41
    v_mul_f32 v42, v147, v42
    v_mul_f32 v43, v147, v43
    v_mul_f32 v44, v147, v44
    v_mul_f32 v45, v147, v45
    v_mul_f32 v46, v147, v46
    v_mul_f32 v47, v147, v47
    v_mul_f32 v48, v147, v48
    v_mul_f32 v49, v147, v49
    v_mul_f32 v50, v147, v50
    v_mul_f32 v51, v147, v51
    v_mul_f32 v52, v147, v52
    v_mul_f32 v53, v147, v53
    v_mul_f32 v54, v147, v54
    v_mul_f32 v55, v147, v55
L_nores:
    s_nop 7
    s_nop 3
    v_fma_f32 v56, v56, s99, -v148
    v_exp_f32 v56, v56
    s_nop 0
    v_add_f32 v146, v146, v56
    v_fma_f32 v57, v57, s99, -v148
    v_exp_f32 v57, v57
    s_nop 0
    v_add_f32 v146, v146, v57
    v_fma_f32 v58, v58, s99, -v148
    v_exp_f32 v58, v58
    s_nop 0
    v_add_f32 v146, v146, v58
    v_fma_f32 v59, v59, s99, -v148
    v_exp_f32 v59, v59
    s_nop 0
    v_add_f32 v146, v146, v59
    v_fma_f32 v60, v60, s99, -v148
    v_exp_f32 v60, v60
    s_nop 0
    v_add_f32 v146, v146, v60
    v_fma_f32 v61, v61, s99, -v148
    v_exp_f32 v61, v61
    s_nop 0
    v_add_f32 v146, v146, v61
    v_fma_f32 v62, v62, s99, -v148
    v_exp_f32 v62, v62
    s_nop 0
    v_add_f32 v146, v146, v62
    v_fma_f32 v63, v63, s99, -v148
    v_exp_f32 v63, v63
    s_nop 0
    v_add_f32 v146, v146, v63
    v_cvt_pk_bf16_f32 v64, v56, v57
    v_cvt_pk_bf16_f32 v65, v58, v59
    v_cvt_pk_bf16_f32 v66, v60, v61
    v_cvt_pk_bf16_f32 v67, v62, v63
    s_nop 1
    v_mfma_f32_16x16x32_bf16 v[24:27], v[100:103], v[64:67], v[24:27]
    v_mfma_f32_16x16x32_bf16 v[28:31], v[104:107], v[64:67], v[28:31]
    v_mfma_f32_16x16x32_bf16 v[32:35], v[108:111], v[64:67], v[32:35]
    v_mfma_f32_16x16x32_bf16 v[36:39], v[112:115], v[64:67], v[36:39]
    v_mfma_f32_16x16x32_bf16 v[40:43], v[116:119], v[64:67], v[40:43]
    v_mfma_f32_16x16x32_bf16 v[44:47], v[120:123], v[64:67], v[44:47]
    v_mfma_f32_16x16x32_bf16 v[48:51], v[124:127], v[64:67], v[48:51]
    v_mfma_f32_16x16x32_bf16 v[52:55], v[128:131], v[64:67], v[52:55]
    s_add_u32 s96, s96, 4
    s_cmp_lt_u32 s96, s67
    s_cbranch_scc1 L_poll
L_cdone:
    s_nop 7
    s_nop 3
    v_mov_b32 v145, v146
    s_nop 1
    v_permlane16_swap_b32 v146, v145
    v_add_f32 v146, v146, v145
    v_mov_b32 v145, v146
    s_nop 1
    v_permlane32_swap_b32 v146, v145
    v_add_f32 v145, v146, v145
    s_lshl_b32 s56, s6, 11
    v_lshlrev_b32 v6, 9, v2
    v_lshl_add_u32 v6, v3, 4, v6
    v_add_u32 v6, s56, v6
    s_lshl_b32 s57, s6, 3
    v_lshlrev_b32 v7, 6, v2
    v_add_u32 v7, s57, v7
    v_cmp_gt_u32 vcc, 4, v2
    s_nop 0
    s_and_saveexec_b64 s[58:59], vcc
    ds_write_b128 v6, v[24:27] offset:0
    ds_write_b128 v6, v[28:31] offset:64
    ds_write_b128 v6, v[32:35] offset:128
    ds_write_b128 v6, v[36:39] offset:192
    ds_write_b128 v6, v[40:43] offset:256
    ds_write_b128 v6, v[44:47] offset:320
    ds_write_b128 v6, v[48:51] offset:384
    ds_write_b128 v6, v[52:55] offset:448
    ds_write_b64 v7, v[144:145] offset:15488
    s_mov_b64 exec, s[58:59]
    v_mov_b32 v9, 0
L_epi0:
    s_nop 7
    s_nop 3
    v_mov_b32 v10, 1
    s_mov_b64 exec, 1
    ds_add_u32 v9, v10 offset:15832
    s_mov_b64 exec, -1
L_epi:
    s_nop 7
    s_nop 3
    s_waitcnt vmcnt(0)
L_epi1:
    s_nop 7
    s_nop 3
    s_mov_b32 s62, 0
L_lwe:
    s_nop 7
    s_nop 3
    ds_read_b32 v10, v9 offset:15832
    s_waitcnt lgkmcnt(0)
    v_readfirstlane_b32 s56, v10
    s_nop 0
    s_cmp_eq_u32 s56, 5
    s_cbranch_scc1 L_lwde
    s_sleep 1
    s_add_u32 s62, s62, 1
    s_cmp_lt_u32 s62, 1048576
    s_cbranch_scc1 L_lwe
L_lwde:
    s_nop 7
    s_nop 3
    s_cmp_ge_u32 s3, 2
    s_cbranch_scc1 L_role
    v_lshrrev_b32 v6, 5, v0
    v_lshlrev_b32 v8, 6, v6
    ds_read_b128 v[24:27], v8 offset:15488
    ds_read_b128 v[28:31], v8 offset:15504
    v_lshlrev_b32 v9, 4, v0
    ds_read_b128 v[40:43], v9 offset:0
    ds_read_b128 v[44:47], v9 offset:2048
    ds_read_b128 v[48:51], v9 offset:4096
    ds_read_b128 v[52:55], v9 offset:6144
    s_waitcnt lgkmcnt(4)
    v_max_f32 v10, v24, v26
    v_max3_f32 v10, v28, v30, v10
    v_mov_b32 v11, 0
    v_sub_f32 v24, v24, v10
    v_mul_f32 v24, s99, v24
    v_exp_f32 v24, v24
    s_nop 0
    v_fmac_f32 v11, v24, v25
    v_sub_f32 v26, v26, v10
    v_mul_f32 v26, s99, v26
    v_exp_f32 v26, v26
    s_nop 0
    v_fmac_f32 v11, v26, v27
    v_sub_f32 v28, v28, v10
    v_mul_f32 v28, s99, v28
    v_exp_f32 v28, v28
    s_nop 0
    v_fmac_f32 v11, v28, v29
    v_sub_f32 v30, v30, v10
    v_mul_f32 v30, s99, v30
    v_exp_f32 v30, v30
    s_nop 0
    v_fmac_f32 v11, v30, v31
    s_waitcnt lgkmcnt(0)
    v_mul_f32 v12, v24, v40
    v_mul_f32 v13, v24, v41
    v_mul_f32 v14, v24, v42
    v_mul_f32 v15, v24, v43
    v_fmac_f32 v12, v26, v44
    v_fmac_f32 v13, v26, v45
    v_fmac_f32 v14, v26, v46
    v_fmac_f32 v15, v26, v47
    v_fmac_f32 v12, v28, v48
    v_fmac_f32 v13, v28, v49
    v_fmac_f32 v14, v28, v50
    v_fmac_f32 v15, v28, v51
    v_fmac_f32 v12, v30, v52
    v_fmac_f32 v13, v30, v53
    v_fmac_f32 v14, v30, v54
    v_fmac_f32 v15, v30, v55
    v_min_u32 v10, -2, v10
    v_min_u32 v11, -2, v11
    v_min_u32 v12, -2, v12
    v_min_u32 v13, -2, v13
    v_min_u32 v14, -2, v14
    v_min_u32 v15, -2, v15
    s_lshl_b32 s56, s14, 11
    s_add_u32 s56, s56, 65536
    buffer_store_dwordx4 v[12:15], v9, s[24:27], s56 offen sc1
    s_lshl_b32 s56, s14, 5
    s_add_u32 s56, s56, 589824
    v_lshlrev_b32 v8, 3, v6
    v_and_b32 v7, 31, v0
    v_cmp_eq_u32 vcc, 0, v7
    s_nop 0
    s_and_saveexec_b64 s[58:59], vcc
    buffer_store_dwordx2 v[10:11], v8, s[24:27], s56 offen sc1
    s_mov_b64 exec, s[58:59]
    v_mov_b32 v9, 0
    v_mov_b32 v16, 1
    s_mov_b64 exec, 1
    ds_add_u32 v9, v16 offset:15836
    s_mov_b64 exec, -1
L_role:
    s_nop 7
    s_nop 3
    s_cmp_ge_u32 s11, 30
    s_cbranch_scc1 L_Z
    s_cmp_ge_u32 s11, 16
    s_cbranch_scc1 L_F
    v_lshrrev_b32 v6, 7, v0
    v_and_b32 v7, 127, v0
    v_lshlrev_b32 v16, 14, v6
    v_lshl_add_u32 v16, v7, 4, v16
    v_lshlrev_b32 v17, 8, v6
    v_lshrrev_b32 v18, 5, v7
    v_lshl_add_u32 v17, v18, 3, v17
    s_lshl_b32 s63, s10, 10
    s_add_u32 s63, s63, 589824
    v_lshrrev_b32 v4, 2, v2
    v_lshl_add_u32 v4, v3, 3, v4
    v_lshlrev_b32 v4, 6, v4
    v_and_b32 v5, 3, v2
    v_lshl_add_u32 v4, v5, 3, v4
    s_lshl_b32 s56, s3, 12
    s_add_u32 s56, s56, 32768
    v_add_u32 v76, s56, v4
    v_lshlrev_b32 v4, 10, v5
    v_lshl_add_u32 v4, v3, 4, v4
    s_lshl_b32 s56, s3, 7
    s_add_u32 s56, s56, 8192
    v_add_u32 v77, s56, v4
    s_mov_b32 s62, 0
    v_lshlrev_b32 v19, 8, v6
    v_lshl_add_u32 v19, v2, 4, v19
    s_mov_b32 s60, s63
L_o1:
    s_nop 7
    s_nop 3
    buffer_load_dwordx4 v[20:23], v19, s[24:27], s63 offen sc1
    s_waitcnt vmcnt(0)
    v_max_u32 v10, v20, v21
    v_max3_u32 v10, v22, v23, v10
    v_cmp_eq_u32 vcc, -1, v10
    s_nop 0
    s_cmp_eq_u64 vcc, 0
    s_cbranch_scc1 L_o1_done
    s_sleep 1
    s_add_u32 s62, s62, 1
    s_cmp_lt_u32 s62, 65536
    s_cbranch_scc1 L_o1
L_o1_done:
    s_nop 7
    s_nop 3
    s_mov_b32 s62, 0
L_o2:
    s_nop 7
    s_nop 3
    s_lshl_b32 s63, s10, 16
    s_add_u32 s63, s63, 65536
    buffer_load_dwordx4 v[36:39], v16, s[24:27], s63 offen offset:0 sc1
    buffer_load_dwordx4 v[40:43], v16, s[24:27], s63 offen offset:2048 sc1
    s_add_u32 s63, s63, 4096
    buffer_load_dwordx4 v[44:47], v16, s[24:27], s63 offen offset:0 sc1
    buffer_load_dwordx4 v[48:51], v16, s[24:27], s63 offen offset:2048 sc1
    s_add_u32 s63, s63, 4096
    buffer_load_dwordx4 v[52:55], v16, s[24:27], s63 offen offset:0 sc1
    buffer_load_dwordx4 v[56:59], v16, s[24:27], s63 offen offset:2048 sc1
    s_add_u32 s63, s63, 4096
    buffer_load_dwordx4 v[60:63], v16, s[24:27], s63 offen offset:0 sc1
    buffer_load_dwordx4 v[64:67], v16, s[24:27], s63 offen offset:2048 sc1
    buffer_load_dwordx2 v[20:21], v17, s[24:27], s60 offen offset:0 sc1
    buffer_load_dwordx2 v[22:23], v17, s[24:27], s60 offen offset:32 sc1
    buffer_load_dwordx2 v[24:25], v17, s[24:27], s60 offen offset:64 sc1
    buffer_load_dwordx2 v[26:27], v17, s[24:27], s60 offen offset:96 sc1
    buffer_load_dwordx2 v[28:29], v17, s[24:27], s60 offen offset:128 sc1
    buffer_load_dwordx2 v[30:31], v17, s[24:27], s60 offen offset:160 sc1
    buffer_load_dwordx2 v[32:33], v17, s[24:27], s60 offen offset:192 sc1
    buffer_load_dwordx2 v[34:35], v17, s[24:27], s60 offen offset:224 sc1
    s_waitcnt vmcnt(0)
    v_max_u32 v10, v20, v21
    v_max3_u32 v10, v22, v23, v10
    v_max3_u32 v10, v24, v25, v10
    v_max3_u32 v10, v26, v27, v10
    v_max3_u32 v10, v28, v29, v10
    v_max3_u32 v10, v30, v31, v10
    v_max3_u32 v10, v32, v33, v10
    v_max3_u32 v10, v34, v35, v10
    v_max3_u32 v10, v36, v37, v10
    v_max3_u32 v10, v38, v39, v10
    v_max3_u32 v10, v40, v41, v10
    v_max3_u32 v10, v42, v43, v10
    v_max3_u32 v10, v44, v45, v10
    v_max3_u32 v10, v46, v47, v10
    v_max3_u32 v10, v48, v49, v10
    v_max3_u32 v10, v50, v51, v10
    v_max3_u32 v10, v52, v53, v10
    v_max3_u32 v10, v54, v55, v10
    v_max3_u32 v10, v56, v57, v10
    v_max3_u32 v10, v58, v59, v10
    v_max3_u32 v10, v60, v61, v10
    v_max3_u32 v10, v62, v63, v10
    v_max3_u32 v10, v64, v65, v10
    v_max3_u32 v10, v66, v67, v10
    v_cmp_eq_u32 vcc, -1, v10
    s_nop 0
    s_cmp_eq_u64 vcc, 0
    s_cbranch_scc1 L_o2_done
    s_sleep 1
    s_add_u32 s62, s62, 1
    s_cmp_lt_u32 s62, 65536
    s_cbranch_scc1 L_o2
L_o2_done:
    s_nop 7
    s_nop 3
    v_max_f32 v10, v20, v22
    v_max_f32 v10, v10, v24
    v_max_f32 v10, v10, v26
    v_max_f32 v10, v10, v28
    v_max_f32 v10, v10, v30
    v_max_f32 v10, v10, v32
    v_max_f32 v10, v10, v34
    v_mov_b32 v11, 0
    v_sub_f32 v20, v20, v10
    v_mul_f32 v20, s99, v20
    v_exp_f32 v20, v20
    s_nop 0
    v_fmac_f32 v11, v20, v21
    v_sub_f32 v22, v22, v10
    v_mul_f32 v22, s99, v22
    v_exp_f32 v22, v22
    s_nop 0
    v_fmac_f32 v11, v22, v23
    v_sub_f32 v24, v24, v10
    v_mul_f32 v24, s99, v24
    v_exp_f32 v24, v24
    s_nop 0
    v_fmac_f32 v11, v24, v25
    v_sub_f32 v26, v26, v10
    v_mul_f32 v26, s99, v26
    v_exp_f32 v26, v26
    s_nop 0
    v_fmac_f32 v11, v26, v27
    v_sub_f32 v28, v28, v10
    v_mul_f32 v28, s99, v28
    v_exp_f32 v28, v28
    s_nop 0
    v_fmac_f32 v11, v28, v29
    v_sub_f32 v30, v30, v10
    v_mul_f32 v30, s99, v30
    v_exp_f32 v30, v30
    s_nop 0
    v_fmac_f32 v11, v30, v31
    v_sub_f32 v32, v32, v10
    v_mul_f32 v32, s99, v32
    v_exp_f32 v32, v32
    s_nop 0
    v_fmac_f32 v11, v32, v33
    v_sub_f32 v34, v34, v10
    v_mul_f32 v34, s99, v34
    v_exp_f32 v34, v34
    s_nop 0
    v_fmac_f32 v11, v34, v35
    v_mul_f32 v12, v20, v36
    v_mul_f32 v13, v20, v37
    v_mul_f32 v14, v20, v38
    v_mul_f32 v15, v20, v39
    v_fmac_f32 v12, v22, v40
    v_fmac_f32 v13, v22, v41
    v_fmac_f32 v14, v22, v42
    v_fmac_f32 v15, v22, v43
    v_fmac_f32 v12, v24, v44
    v_fmac_f32 v13, v24, v45
    v_fmac_f32 v14, v24, v46
    v_fmac_f32 v15, v24, v47
    v_fmac_f32 v12, v26, v48
    v_fmac_f32 v13, v26, v49
    v_fmac_f32 v14, v26, v50
    v_fmac_f32 v15, v26, v51
    v_fmac_f32 v12, v28, v52
    v_fmac_f32 v13, v28, v53
    v_fmac_f32 v14, v28, v54
    v_fmac_f32 v15, v28, v55
    v_fmac_f32 v12, v30, v56
    v_fmac_f32 v13, v30, v57
    v_fmac_f32 v14, v30, v58
    v_fmac_f32 v15, v30, v59
    v_fmac_f32 v12, v32, v60
    v_fmac_f32 v13, v32, v61
    v_fmac_f32 v14, v32, v62
    v_fmac_f32 v15, v32, v63
    v_fmac_f32 v12, v34, v64
    v_fmac_f32 v13, v34, v65
    v_fmac_f32 v14, v34, v66
    v_fmac_f32 v15, v34, v67
    v_rcp_f32 v10, v11
    s_nop 0
    v_mul_f32 v18, v12, v10
    v_fma_f32 v19, -v18, v11, v12
    v_fma_f32 v12, v19, v10, v18
    v_mul_f32 v18, v13, v10
    v_fma_f32 v19, -v18, v11, v13
    v_fma_f32 v13, v19, v10, v18
    v_mul_f32 v18, v14, v10
    v_fma_f32 v19, -v18, v11, v14
    v_fma_f32 v14, v19, v10, v18
    v_mul_f32 v18, v15, v10
    v_fma_f32 v19, -v18, v11, v15
    v_fma_f32 v15, v19, v10, v18
    v_cvt_pk_bf16_f32 v12, v12, v13
    v_cvt_pk_bf16_f32 v13, v14, v15
    v_lshlrev_b32 v10, 3, v0
    ds_write_b64 v10, v[12:13] offset:8192
    s_waitcnt lgkmcnt(0)
    s_barrier
    ds_read_b64_tr_b16 v[80:81], v76 offset:0
    ds_read_b64_tr_b16 v[82:83], v76 offset:256
    ds_read_b64_tr_b16 v[84:85], v76 offset:2048
    ds_read_b64_tr_b16 v[86:87], v76 offset:2304
    ds_read_b64_tr_b16 v[88:89], v76 offset:32
    ds_read_b64_tr_b16 v[90:91], v76 offset:288
    ds_read_b64_tr_b16 v[92:93], v76 offset:2080
    ds_read_b64_tr_b16 v[94:95], v76 offset:2336
    ds_read_b128 v[96:99], v77 offset:0
    ds_read_b128 v[100:103], v77 offset:64
    s_waitcnt lgkmcnt(0)
    v_mfma_f32_16x16x32_bf16 v[36:39], v[80:83], v[96:99], 0
    v_mfma_f32_16x16x32_bf16 v[56:59], v[88:91], v[96:99], 0
    v_mfma_f32_16x16x32_bf16 v[36:39], v[84:87], v[100:103], v[36:39]
    v_mfma_f32_16x16x32_bf16 v[56:59], v[92:95], v[100:103], v[56:59]
    s_lshl_b32 s56, s3, 9
    s_add_u32 s56, s56, 0
    v_lshlrev_b32 v4, 7, v2
    v_lshl_add_u32 v4, v3, 4, v4
    v_add_u32 v4, s56, v4
    v_cmp_gt_u32 vcc, 4, v2
    s_nop 0
    s_and_saveexec_b64 s[58:59], vcc
    ds_write_b128 v4, v[36:39]
    ds_write_b128 v4, v[56:59] offset:64
    s_mov_b64 exec, s[58:59]
    s_waitcnt lgkmcnt(0)
    s_barrier
    s_cmp_lg_u32 s3, 0
    s_cbranch_scc1 L_fin
    v_and_b32 v5, 31, v1
    v_lshlrev_b32 v4, 4, v5
    ds_read_b128 v[8:11], v4 offset:0
    ds_read_b128 v[12:15], v4 offset:512
    ds_read_b128 v[16:19], v4 offset:1024
    ds_read_b128 v[20:23], v4 offset:1536
    ds_read_b128 v[24:27], v4 offset:2048
    ds_read_b128 v[28:31], v4 offset:2560
    ds_read_b128 v[32:35], v4 offset:3072
    ds_read_b128 v[36:39], v4 offset:3584
    v_lshrrev_b32 v4, 3, v5
    v_lshlrev_b32 v4, 11, v4
    v_and_b32 v5, 7, v5
    v_lshl_add_u32 v4, v5, 4, v4
    s_lshl_b32 s56, s10, 13
    s_lshl_b32 s57, s11, 7
    s_add_u32 s56, s56, s57
    s_add_u32 s56, s56, 655360
    s_waitcnt lgkmcnt(0)
    v_add_f32 v8, v8, v12
    v_add_f32 v9, v9, v13
    v_add_f32 v10, v10, v14
    v_add_f32 v11, v11, v15
    v_add_f32 v8, v8, v16
    v_add_f32 v9, v9, v17
    v_add_f32 v10, v10, v18
    v_add_f32 v11, v11, v19
    v_add_f32 v8, v8, v20
    v_add_f32 v9, v9, v21
    v_add_f32 v10, v10, v22
    v_add_f32 v11, v11, v23
    v_add_f32 v8, v8, v24
    v_add_f32 v9, v9, v25
    v_add_f32 v10, v10, v26
    v_add_f32 v11, v11, v27
    v_add_f32 v8, v8, v28
    v_add_f32 v9, v9, v29
    v_add_f32 v10, v10, v30
    v_add_f32 v11, v11, v31
    v_add_f32 v8, v8, v32
    v_add_f32 v9, v9, v33
    v_add_f32 v10, v10, v34
    v_add_f32 v11, v11, v35
    v_add_f32 v8, v8, v36
    v_add_f32 v9, v9, v37
    v_add_f32 v10, v10, v38
    v_add_f32 v11, v11, v39
    v_min_u32 v8, -2, v8
    v_min_u32 v9, -2, v9
    v_min_u32 v10, -2, v10
    v_min_u32 v11, -2, v11
    s_mov_b32 exec_lo, -1
    s_mov_b32 exec_hi, 0
    buffer_store_dwordx4 v[8:11], v4, s[24:27], s56 offen sc1
    s_mov_b64 exec, -1
    s_branch L_fin
L_F:
    s_nop 7
    s_nop 3
    v_lshlrev_b32 v16, 4, v0
    v_lshlrev_b32 v17, 3, v0
    buffer_load_dwordx2 v[18:19], v17, s[28:31], 0 offen
    v_lshrrev_b32 v4, 2, v2
    v_lshl_add_u32 v4, v3, 3, v4
    v_lshlrev_b32 v4, 5, v4
    v_and_b32 v5, 3, v2
    v_lshl_add_u32 v4, v5, 3, v4
    s_lshl_b32 s56, s3, 11
    s_add_u32 s56, s56, 32768
    v_add_u32 v76, s56, v4
    v_lshlrev_b32 v4, 10, v5
    v_lshl_add_u32 v4, v3, 4, v4
    s_lshl_b32 s56, s3, 7
    s_add_u32 s56, s56, 8192
    v_add_u32 v77, s56, v4
    v_and_b32 v5, 3, v2
    v_lshlrev_b32 v79, 5, v5
    v_lshl_add_u32 v79, v3, 3, v79
    v_lshrrev_b32 v78, 2, v2
    v_lshl_add_u32 v78, v3, 2, v78
    v_lshlrev_b32 v78, 10, v78
    v_lshl_add_u32 v78, v5, 3, v78
    s_lshl_b32 s56, s3, 7
    s_add_u32 s56, s56, 65536
    v_add_u32 v78, s56, v78
    s_and_b32 s63, s15, 7
    s_lshl_b32 s63, s63, 13
    s_add_u32 s63, s63, 655360
    s_mov_b32 s62, 0
    v_and_b32 v20, 7, v1
    v_lshlrev_b32 v20, 13, v20
    s_and_b32 s63, s15, 7
    s_lshl_b32 s63, s63, 7
    s_lshl_b32 s56, s3, 10
    s_add_u32 s63, s63, s56
    s_add_u32 s63, s63, 655360
L_f1:
    s_nop 7
    s_nop 3
    buffer_load_dword v36, v20, s[24:27], s63 offen sc1
    s_waitcnt vmcnt(0)
    v_max_u32 v10, v36, v36
    v_cmp_eq_u32 vcc, -1, v10
    s_nop 0
    s_cmp_eq_u64 vcc, 0
    s_cbranch_scc1 L_f1_done
    s_sleep 1
    s_add_u32 s62, s62, 1
    s_cmp_lt_u32 s62, 65536
    s_cbranch_scc1 L_f1
L_f1_done:
    s_nop 7
    s_nop 3
    s_mov_b32 s62, 0
L_f2:
    s_nop 7
    s_nop 3
    s_mov_b32 s63, 655360
    buffer_load_dwordx4 v[36:39], v16, s[24:27], s63 offen sc1
    s_add_u32 s63, s63, 8192
    buffer_load_dwordx4 v[40:43], v16, s[24:27], s63 offen sc1
    s_add_u32 s63, s63, 8192
    buffer_load_dwordx4 v[44:47], v16, s[24:27], s63 offen sc1
    s_add_u32 s63, s63, 8192
    buffer_load_dwordx4 v[48:51], v16, s[24:27], s63 offen sc1
    s_add_u32 s63, s63, 8192
    buffer_load_dwordx4 v[52:55], v16, s[24:27], s63 offen sc1
    s_add_u32 s63, s63, 8192
    buffer_load_dwordx4 v[56:59], v16, s[24:27], s63 offen sc1
    s_add_u32 s63, s63, 8192
    buffer_load_dwordx4 v[60:63], v16, s[24:27], s63 offen sc1
    s_add_u32 s63, s63, 8192
    buffer_load_dwordx4 v[64:67], v16, s[24:27], s63 offen sc1
    s_waitcnt vmcnt(0)
    v_max_u32 v10, v36, v37
    v_max3_u32 v10, v38, v39, v10
    v_max3_u32 v10, v40, v41, v10
    v_max3_u32 v10, v42, v43, v10
    v_max3_u32 v10, v44, v45, v10
    v_max3_u32 v10, v46, v47, v10
    v_max3_u32 v10, v48, v49, v10
    v_max3_u32 v10, v50, v51, v10
    v_max3_u32 v10, v52, v53, v10
    v_max3_u32 v10, v54, v55, v10
    v_max3_u32 v10, v56, v57, v10
    v_max3_u32 v10, v58, v59, v10
    v_max3_u32 v10, v60, v61, v10
    v_max3_u32 v10, v62, v63, v10
    v_max3_u32 v10, v64, v65, v10
    v_max3_u32 v10, v66, v67, v10
    v_cmp_eq_u32 vcc, -1, v10
    s_nop 0
    s_cmp_eq_u64 vcc, 0
    s_cbranch_scc1 L_f2_done
    s_sleep 1
    s_add_u32 s62, s62, 1
    s_cmp_lt_u32 s62, 65536
    s_cbranch_scc1 L_f2
L_f2_done:
    s_nop 7
    s_nop 3
    v_add_f32 v36, v36, v40
    v_add_f32 v37, v37, v41
    v_add_f32 v38, v38, v42
    v_add_f32 v39, v39, v43
    v_add_f32 v36, v36, v44
    v_add_f32 v37, v37, v45
    v_add_f32 v38, v38, v46
    v_add_f32 v39, v39, v47
    v_add_f32 v36, v36, v48
    v_add_f32 v37, v37, v49
    v_add_f32 v38, v38, v50
    v_add_f32 v39, v39, v51
    v_add_f32 v36, v36, v52
    v_add_f32 v37, v37, v53
    v_add_f32 v38, v38, v54
    v_add_f32 v39, v39, v55
    v_add_f32 v36, v36, v56
    v_add_f32 v37, v37, v57
    v_add_f32 v38, v38, v58
    v_add_f32 v39, v39, v59
    v_add_f32 v36, v36, v60
    v_add_f32 v37, v37, v61
    v_add_f32 v38, v38, v62
    v_add_f32 v39, v39, v63
    v_add_f32 v36, v36, v64
    v_add_f32 v37, v37, v65
    v_add_f32 v38, v38, v66
    v_add_f32 v39, v39, v67
    v_cvt_pk_bf16_f32 v36, v36, v36
    v_lshlrev_b32 v36, 16, v36
    v_cvt_pk_bf16_f32 v37, v37, v37
    v_lshlrev_b32 v37, 16, v37
    v_cvt_pk_bf16_f32 v38, v38, v38
    v_lshlrev_b32 v38, 16, v38
    v_cvt_pk_bf16_f32 v39, v39, v39
    v_lshlrev_b32 v39, 16, v39
    v_lshlrev_b32 v40, 16, v18
    v_and_b32 v41, 0xffff0000, v18
    v_lshlrev_b32 v42, 16, v19
    v_and_b32 v43, 0xffff0000, v19
    v_add_f32 v36, v36, v40
    v_add_f32 v37, v37, v41
    v_add_f32 v38, v38, v42
    v_add_f32 v39, v39, v43
    v_cvt_pk_bf16_f32 v36, v36, v37
    v_cvt_pk_bf16_f32 v37, v38, v39
    ds_write_b64 v17, v[36:37] offset:4096
    s_waitcnt lgkmcnt(0)
    s_barrier
    ds_read_b128 v[16:19], v16 offset:4096
    ds_read_b64_tr_b16 v[80:81], v76 offset:0
    ds_read_b64_tr_b16 v[82:83], v76 offset:128
    ds_read_b64_tr_b16 v[84:85], v76 offset:1024
    ds_read_b64_tr_b16 v[86:87], v76 offset:1152
    ds_read_b64_tr_b16 v[88:89], v76 offset:16384
    ds_read_b64_tr_b16 v[90:91], v76 offset:16512
    ds_read_b64_tr_b16 v[92:93], v76 offset:17408
    ds_read_b64_tr_b16 v[94:95], v76 offset:17536
    ds_read_b64_tr_b16 v[104:105], v78 offset:0
    ds_read_b64_tr_b16 v[106:107], v78 offset:32
    ds_read_b64_tr_b16 v[108:109], v78 offset:64
    ds_read_b64_tr_b16 v[110:111], v78 offset:96
    s_cmp_ge_u32 s3, 4
    s_cbranch_scc1 L_f_skip
    v_lshlrev_b32 v6, 4, v0
    s_waitcnt lgkmcnt(12)
    v_lshlrev_b32 v20, 16, v16
    v_and_b32 v21, 0xffff0000, v16
    v_lshlrev_b32 v22, 16, v17
    v_and_b32 v23, 0xffff0000, v17
    v_lshlrev_b32 v24, 16, v18
    v_and_b32 v25, 0xffff0000, v18
    v_lshlrev_b32 v26, 16, v19
    v_and_b32 v27, 0xffff0000, v19
    v_add_f32 v28, v20, v21
    v_add_f32 v28, v28, v22
    v_add_f32 v28, v28, v23
    v_add_f32 v28, v28, v24
    v_add_f32 v28, v28, v25
    v_add_f32 v28, v28, v26
    v_add_f32 v28, v28, v27
    s_nop 1
    v_add_f32_dpp v28, v28, v28 quad_perm:[1,0,3,2] row_mask:0xf bank_mask:0xf
    s_nop 1
    v_add_f32_dpp v28, v28, v28 quad_perm:[2,3,0,1] row_mask:0xf bank_mask:0xf
    s_nop 1
    v_add_f32_dpp v28, v28, v28 row_half_mirror row_mask:0xf bank_mask:0xf
    s_nop 1
    v_add_f32_dpp v28, v28, v28 row_mirror row_mask:0xf bank_mask:0xf
    v_mov_b32 v29, v28
    s_nop 1
    v_permlane16_swap_b32 v28, v29
    v_add_f32 v28, v28, v29
    v_mov_b32 v29, v28
    s_nop 1
    v_permlane32_swap_b32 v28, v29
    v_add_f32 v28, v28, v29
    v_mul_f32 v28, 0x3b000000, v28
    v_sub_f32 v29, v20, v28
    v_mul_f32 v30, v29, v29
    v_sub_f32 v29, v21, v28
    v_fmac_f32 v30, v29, v29
    v_sub_f32 v29, v22, v28
    v_fmac_f32 v30, v29, v29
    v_sub_f32 v29, v23, v28
    v_fmac_f32 v30, v29, v29
    v_sub_f32 v29, v24, v28
    v_fmac_f32 v30, v29, v29
    v_sub_f32 v29, v25, v28
    v_fmac_f32 v30, v29, v29
    v_sub_f32 v29, v26, v28
    v_fmac_f32 v30, v29, v29
    v_sub_f32 v29, v27, v28
    v_fmac_f32 v30, v29, v29
    s_nop 1
    v_add_f32_dpp v30, v30, v30 quad_perm:[1,0,3,2] row_mask:0xf bank_mask:0xf
    s_nop 1
    v_add_f32_dpp v30, v30, v30 quad_perm:[2,3,0,1] row_mask:0xf bank_mask:0xf
    s_nop 1
    v_add_f32_dpp v30, v30, v30 row_half_mirror row_mask:0xf bank_mask:0xf
    s_nop 1
    v_add_f32_dpp v30, v30, v30 row_mirror row_mask:0xf bank_mask:0xf
    v_mov_b32 v29, v30
    s_nop 1
    v_permlane16_swap_b32 v30, v29
    v_add_f32 v30, v30, v29
    v_mov_b32 v29, v30
    s_nop 1
    v_permlane32_swap_b32 v30, v29
    v_add_f32 v30, v30, v29
    v_mul_f32 v30, 0x3b000000, v30
    v_cvt_pk_bf16_f32 v28, v28, v28
    v_lshlrev_b32 v28, 16, v28
    v_cvt_pk_bf16_f32 v30, v30, v30
    v_lshlrev_b32 v30, 16, v30
    v_add_f32 v30, 0x3727c5ac, v30
    v_cvt_pk_bf16_f32 v30, v30, v30
    v_lshlrev_b32 v30, 16, v30
    v_sqrt_f32 v30, v30
    s_nop 0
    v_cvt_pk_bf16_f32 v30, v30, v30
    v_lshlrev_b32 v30, 16, v30
    v_rcp_f32 v31, v30
    v_sub_f32 v20, v20, v28
    v_cvt_pk_bf16_f32 v20, v20, v20
    v_lshlrev_b32 v20, 16, v20
    v_mul_f32 v32, v20, v31
    v_fma_f32 v33, -v32, v30, v20
    v_fma_f32 v20, v33, v31, v32
    v_sub_f32 v21, v21, v28
    v_cvt_pk_bf16_f32 v21, v21, v21
    v_lshlrev_b32 v21, 16, v21
    v_mul_f32 v32, v21, v31
    v_fma_f32 v33, -v32, v30, v21
    v_fma_f32 v21, v33, v31, v32
    v_sub_f32 v22, v22, v28
    v_cvt_pk_bf16_f32 v22, v22, v22
    v_lshlrev_b32 v22, 16, v22
    v_mul_f32 v32, v22, v31
    v_fma_f32 v33, -v32, v30, v22
    v_fma_f32 v22, v33, v31, v32
    v_sub_f32 v23, v23, v28
    v_cvt_pk_bf16_f32 v23, v23, v23
    v_lshlrev_b32 v23, 16, v23
    v_mul_f32 v32, v23, v31
    v_fma_f32 v33, -v32, v30, v23
    v_fma_f32 v23, v33, v31, v32
    v_sub_f32 v24, v24, v28
    v_cvt_pk_bf16_f32 v24, v24, v24
    v_lshlrev_b32 v24, 16, v24
    v_mul_f32 v32, v24, v31
    v_fma_f32 v33, -v32, v30, v24
    v_fma_f32 v24, v33, v31, v32
    v_sub_f32 v25, v25, v28
    v_cvt_pk_bf16_f32 v25, v25, v25
    v_lshlrev_b32 v25, 16, v25
    v_mul_f32 v32, v25, v31
    v_fma_f32 v33, -v32, v30, v25
    v_fma_f32 v25, v33, v31, v32
    v_sub_f32 v26, v26, v28
    v_cvt_pk_bf16_f32 v26, v26, v26
    v_lshlrev_b32 v26, 16, v26
    v_mul_f32 v32, v26, v31
    v_fma_f32 v33, -v32, v30, v26
    v_fma_f32 v26, v33, v31, v32
    v_sub_f32 v27, v27, v28
    v_cvt_pk_bf16_f32 v27, v27, v27
    v_lshlrev_b32 v27, 16, v27
    v_mul_f32 v32, v27, v31
    v_fma_f32 v33, -v32, v30, v27
    v_fma_f32 v27, v33, v31, v32
    v_cvt_pk_bf16_f32 v16, v20, v21
    v_cvt_pk_bf16_f32 v17, v22, v23
    v_cvt_pk_bf16_f32 v18, v24, v25
    v_cvt_pk_bf16_f32 v19, v26, v27
    ds_write_b128 v6, v[16:19] offset:8192
L_f_skip:
    s_nop 7
    s_nop 3
    s_waitcnt lgkmcnt(0)
    s_barrier
    ds_read_b128 v[96:99], v77 offset:0
    ds_read_b128 v[100:103], v77 offset:64
    s_waitcnt lgkmcnt(0)
    v_mfma_f32_16x16x32_bf16 v[36:39], v[80:83], v[96:99], 0
    v_mfma_f32_16x16x32_bf16 v[56:59], v[88:91], v[96:99], 0
    v_mfma_f32_16x16x32_bf16 v[36:39], v[84:87], v[100:103], v[36:39]
    v_mfma_f32_16x16x32_bf16 v[56:59], v[92:95], v[100:103], v[56:59]
    s_lshl_b32 s56, s3, 8
    s_add_u32 s56, s56, 0
    v_lshlrev_b32 v4, 6, v2
    v_lshl_add_u32 v4, v3, 4, v4
    v_add_u32 v4, s56, v4
    v_cmp_gt_u32 vcc, 4, v2
    s_nop 0
    s_and_saveexec_b64 s[58:59], vcc
    ds_write_b128 v4, v[36:39]
    ds_write_b128 v4, v[56:59] offset:2048
    s_mov_b64 exec, s[58:59]
    s_waitcnt lgkmcnt(0)
    s_barrier
    s_cmp_ge_u32 s3, 1
    s_cbranch_scc1 L_f_skip2
    v_lshlrev_b32 v4, 2, v1
    ds_read_b32 v8, v4 offset:0
    ds_read_b32 v16, v4 offset:2048
    ds_read_b32 v9, v4 offset:256
    ds_read_b32 v17, v4 offset:2304
    ds_read_b32 v10, v4 offset:512
    ds_read_b32 v18, v4 offset:2560
    ds_read_b32 v11, v4 offset:768
    ds_read_b32 v19, v4 offset:2816
    ds_read_b32 v12, v4 offset:1024
    ds_read_b32 v20, v4 offset:3072
    ds_read_b32 v13, v4 offset:1280
    ds_read_b32 v21, v4 offset:3328
    ds_read_b32 v14, v4 offset:1536
    ds_read_b32 v22, v4 offset:3584
    ds_read_b32 v15, v4 offset:1792
    ds_read_b32 v23, v4 offset:3840
    s_waitcnt lgkmcnt(0)
    v_add_f32 v8, v8, v9
    v_add_f32 v16, v16, v17
    v_add_f32 v8, v8, v10
    v_add_f32 v16, v16, v18
    v_add_f32 v8, v8, v11
    v_add_f32 v16, v16, v19
    v_add_f32 v8, v8, v12
    v_add_f32 v16, v16, v20
    v_add_f32 v8, v8, v13
    v_add_f32 v16, v16, v21
    v_add_f32 v8, v8, v14
    v_add_f32 v16, v16, v22
    v_add_f32 v8, v8, v15
    v_add_f32 v16, v16, v23
    v_cvt_pk_bf16_f32 v8, v8, v8
    v_lshlrev_b32 v8, 16, v8
    v_cvt_pk_bf16_f32 v16, v16, v16
    v_lshlrev_b32 v16, 16, v16
    v_mul_f32 v9, v8, v8
    v_mul_f32 v9, 0x3d372713, v9
    v_fma_f32 v9, v9, v8, v8
    v_mul_f32 v9, 0xc0135761, v9
    v_exp_f32 v9, v9
    s_nop 0
    v_add_f32 v9, 1.0, v9
    v_rcp_f32 v10, v9
    s_nop 0
    v_mul_f32 v11, v8, v10
    v_fma_f32 v12, -v11, v9, v8
    v_fma_f32 v12, v12, v10, v11
    v_cmp_gt_f32 vcc, 0x7f000000, v9
    s_nop 1
    v_cndmask_b32 v11, v11, v12, vcc
    v_cvt_pk_bf16_f32 v11, v11, v11
    v_lshlrev_b32 v11, 16, v11
    v_mul_f32 v11, v11, v16
    v_cvt_pk_bf16_f32 v11, v11, v11
    v_lshlrev_b32 v4, 1, v1
    ds_write_b16 v4, v11 offset:16128
L_f_skip2:
    s_nop 7
    s_nop 3
    s_waitcnt lgkmcnt(0)
    s_barrier
    ds_read_b64 v[8:9], v79 offset:16128
    s_waitcnt lgkmcnt(0)
    v_mfma_f32_16x16x16_bf16 v[20:23], v[104:105], v[8:9], 0
    v_mfma_f32_16x16x16_bf16 v[24:27], v[106:107], v[8:9], 0
    v_mfma_f32_16x16x16_bf16 v[28:31], v[108:109], v[8:9], 0
    v_mfma_f32_16x16x16_bf16 v[32:35], v[110:111], v[8:9], 0
    v_lshlrev_b32 v4, 11, v2
    v_lshl_add_u32 v4, v3, 4, v4
    s_lshl_b32 s56, s15, 13
    s_lshl_b32 s57, s3, 8
    s_add_u32 s56, s56, s57
    s_add_u32 s56, s56, 786432
    v_min_u32 v20, -2, v20
    v_min_u32 v21, -2, v21
    v_min_u32 v22, -2, v22
    v_min_u32 v23, -2, v23
    v_min_u32 v24, -2, v24
    v_min_u32 v25, -2, v25
    v_min_u32 v26, -2, v26
    v_min_u32 v27, -2, v27
    v_min_u32 v28, -2, v28
    v_min_u32 v29, -2, v29
    v_min_u32 v30, -2, v30
    v_min_u32 v31, -2, v31
    v_min_u32 v32, -2, v32
    v_min_u32 v33, -2, v33
    v_min_u32 v34, -2, v34
    v_min_u32 v35, -2, v35
    v_cmp_gt_u32 vcc, 4, v2
    s_nop 0
    s_and_saveexec_b64 s[58:59], vcc
    buffer_store_dwordx4 v[20:23], v4, s[24:27], s56 offen offset:0 sc1
    buffer_store_dwordx4 v[24:27], v4, s[24:27], s56 offen offset:64 sc1
    buffer_store_dwordx4 v[28:31], v4, s[24:27], s56 offen offset:128 sc1
    buffer_store_dwordx4 v[32:35], v4, s[24:27], s56 offen offset:192 sc1
    s_mov_b64 exec, s[58:59]
    s_branch L_fin
L_Z:
    s_nop 7
    s_nop 3
    v_and_b32 v4, 31, v0
    v_lshrrev_b32 v5, 5, v0
    v_lshlrev_b32 v16, 13, v5
    v_lshl_add_u32 v16, v4, 4, v16
    v_lshlrev_b32 v17, 4, v4
    v_lshlrev_b32 v18, 3, v4
    s_lshl_b32 s57, s15, 8
    buffer_load_dwordx2 v[6:7], v18, s[28:31], s57 offen
    s_mov_b32 s62, 0
L_z1:
    s_nop 7
    s_nop 3
    s_lshl_b32 s63, s15, 9
    s_add_u32 s63, s63, 655360
    buffer_load_dwordx4 v[36:39], v17, s[24:27], s63 offen sc1
    s_add_u32 s63, s63, 8192
    buffer_load_dwordx4 v[40:43], v17, s[24:27], s63 offen sc1
    s_add_u32 s63, s63, 8192
    buffer_load_dwordx4 v[44:47], v17, s[24:27], s63 offen sc1
    s_add_u32 s63, s63, 8192
    buffer_load_dwordx4 v[48:51], v17, s[24:27], s63 offen sc1
    s_add_u32 s63, s63, 8192
    buffer_load_dwordx4 v[52:55], v17, s[24:27], s63 offen sc1
    s_add_u32 s63, s63, 8192
    buffer_load_dwordx4 v[56:59], v17, s[24:27], s63 offen sc1
    s_add_u32 s63, s63, 8192
    buffer_load_dwordx4 v[60:63], v17, s[24:27], s63 offen sc1
    s_add_u32 s63, s63, 8192
    buffer_load_dwordx4 v[64:67], v17, s[24:27], s63 offen sc1
    s_waitcnt vmcnt(0)
    v_max_u32 v10, v36, v37
    v_max3_u32 v10, v38, v39, v10
    v_max3_u32 v10, v40, v41, v10
    v_max3_u32 v10, v42, v43, v10
    v_max3_u32 v10, v44, v45, v10
    v_max3_u32 v10, v46, v47, v10
    v_max3_u32 v10, v48, v49, v10
    v_max3_u32 v10, v50, v51, v10
    v_max3_u32 v10, v52, v53, v10
    v_max3_u32 v10, v54, v55, v10
    v_max3_u32 v10, v56, v57, v10
    v_max3_u32 v10, v58, v59, v10
    v_max3_u32 v10, v60, v61, v10
    v_max3_u32 v10, v62, v63, v10
    v_max3_u32 v10, v64, v65, v10
    v_max3_u32 v10, v66, v67, v10
    v_cmp_eq_u32 vcc, -1, v10
    s_nop 0
    s_cmp_eq_u64 vcc, 0
    s_cbranch_scc1 L_z1_done
    s_sleep 4
    s_add_u32 s62, s62, 1
    s_cmp_lt_u32 s62, 65536
    s_cbranch_scc1 L_z1
L_z1_done:
    s_nop 7
    s_nop 3
    v_add_f32 v36, v36, v40
    v_add_f32 v37, v37, v41
    v_add_f32 v38, v38, v42
    v_add_f32 v39, v39, v43
    v_add_f32 v36, v36, v44
    v_add_f32 v37, v37, v45
    v_add_f32 v38, v38, v46
    v_add_f32 v39, v39, v47
    v_add_f32 v36, v36, v48
    v_add_f32 v37, v37, v49
    v_add_f32 v38, v38, v50
    v_add_f32 v39, v39, v51
    v_add_f32 v36, v36, v52
    v_add_f32 v37, v37, v53
    v_add_f32 v38, v38, v54
    v_add_f32 v39, v39, v55
    v_add_f32 v36, v36, v56
    v_add_f32 v37, v37, v57
    v_add_f32 v38, v38, v58
    v_add_f32 v39, v39, v59
    v_add_f32 v36, v36, v60
    v_add_f32 v37, v37, v61
    v_add_f32 v38, v38, v62
    v_add_f32 v39, v39, v63
    v_add_f32 v36, v36, v64
    v_add_f32 v37, v37, v65
    v_add_f32 v38, v38, v66
    v_add_f32 v39, v39, v67
    v_cvt_pk_bf16_f32 v36, v36, v36
    v_lshlrev_b32 v36, 16, v36
    v_cvt_pk_bf16_f32 v37, v37, v37
    v_lshlrev_b32 v37, 16, v37
    v_cvt_pk_bf16_f32 v38, v38, v38
    v_lshlrev_b32 v38, 16, v38
    v_cvt_pk_bf16_f32 v39, v39, v39
    v_lshlrev_b32 v39, 16, v39
    v_lshlrev_b32 v40, 16, v6
    v_and_b32 v41, 0xffff0000, v6
    v_lshlrev_b32 v42, 16, v7
    v_and_b32 v43, 0xffff0000, v7
    v_add_f32 v72, v36, v40
    v_add_f32 v73, v37, v41
    v_add_f32 v74, v38, v42
    v_add_f32 v75, v39, v43
    v_cvt_pk_bf16_f32 v72, v72, v72
    v_lshlrev_b32 v72, 16, v72
    v_cvt_pk_bf16_f32 v73, v73, v73
    v_lshlrev_b32 v73, 16, v73
    v_cvt_pk_bf16_f32 v74, v74, v74
    v_lshlrev_b32 v74, 16, v74
    v_cvt_pk_bf16_f32 v75, v75, v75
    v_lshlrev_b32 v75, 16, v75
    s_lshl_b32 s63, s15, 9
    s_add_u32 s63, s63, 786432
    s_add_u32 s64, s63, 131072
    s_add_u32 s65, s63, 262144
    s_add_u32 s66, s63, 393216
    s_add_u32 s67, s63, 524288
    s_add_u32 s68, s63, 655360
    s_add_u32 s69, s63, 786432
    s_mov_b32 s62, 0
L_z3:
    s_nop 7
    s_nop 3
    buffer_load_dwordx4 v[36:39], v16, s[24:27], s63 offen sc1
    buffer_load_dwordx4 v[40:43], v16, s[24:27], s64 offen sc1
    buffer_load_dwordx4 v[44:47], v16, s[24:27], s65 offen sc1
    buffer_load_dwordx4 v[48:51], v16, s[24:27], s66 offen sc1
    buffer_load_dwordx4 v[52:55], v16, s[24:27], s67 offen sc1
    buffer_load_dwordx4 v[56:59], v16, s[24:27], s68 offen sc1
    buffer_load_dwordx4 v[60:63], v16, s[24:27], s69 offen sc1
    s_waitcnt vmcnt(0)
    v_max_u32 v10, v36, v37
    v_max3_u32 v10, v38, v39, v10
    v_max3_u32 v10, v40, v41, v10
    v_max3_u32 v10, v42, v43, v10
    v_max3_u32 v10, v44, v45, v10
    v_max3_u32 v10, v46, v47, v10
    v_max3_u32 v10, v48, v49, v10
    v_max3_u32 v10, v50, v51, v10
    v_max3_u32 v10, v52, v53, v10
    v_max3_u32 v10, v54, v55, v10
    v_max3_u32 v10, v56, v57, v10
    v_max3_u32 v10, v58, v59, v10
    v_max3_u32 v10, v60, v61, v10
    v_max3_u32 v10, v62, v63, v10
    v_cmp_eq_u32 vcc, -1, v10
    s_nop 0
    s_cmp_eq_u64 vcc, 0
    s_cbranch_scc1 L_z3_done
    s_sleep 1
    s_add_u32 s62, s62, 1
    s_cmp_lt_u32 s62, 65536
    s_cbranch_scc1 L_z3
L_z3_done:
    s_nop 7
    s_nop 3
    v_add_f32 v28, v36, v40
    v_add_f32 v29, v37, v41
    v_add_f32 v30, v38, v42
    v_add_f32 v31, v39, v43
    v_add_f32 v28, v28, v44
    v_add_f32 v29, v29, v45
    v_add_f32 v30, v30, v46
    v_add_f32 v31, v31, v47
    v_add_f32 v28, v28, v48
    v_add_f32 v29, v29, v49
    v_add_f32 v30, v30, v50
    v_add_f32 v31, v31, v51
    v_add_f32 v28, v28, v52
    v_add_f32 v29, v29, v53
    v_add_f32 v30, v30, v54
    v_add_f32 v31, v31, v55
    v_add_f32 v28, v28, v56
    v_add_f32 v29, v29, v57
    v_add_f32 v30, v30, v58
    v_add_f32 v31, v31, v59
    v_add_f32 v28, v28, v60
    v_add_f32 v29, v29, v61
    v_add_f32 v30, v30, v62
    v_add_f32 v31, v31, v63
    v_mov_b32 v32, v28
    s_nop 1
    v_permlane32_swap_b32 v28, v32
    v_mov_b32 v33, v29
    s_nop 1
    v_permlane32_swap_b32 v29, v33
    v_mov_b32 v34, v30
    s_nop 1
    v_permlane32_swap_b32 v30, v34
    v_mov_b32 v35, v31
    s_nop 1
    v_permlane32_swap_b32 v31, v35
    v_add_f32 v28, v28, v32
    v_add_f32 v29, v29, v33
    v_add_f32 v30, v30, v34
    v_add_f32 v31, v31, v35
    s_lshl_b32 s56, s3, 9
    v_add_u32 v6, s56, v17
    ds_write_b128 v6, v[28:31] offset:0
    s_waitcnt lgkmcnt(0)
    s_barrier
    s_cmp_lg_u32 s3, 0
    s_cbranch_scc1 L_fin
    ds_read_b128 v[136:139], v17 offset:512
    ds_read_b128 v[140:143], v17 offset:1024
    ds_read_b128 v[144:147], v17 offset:1536
    ds_read_b128 v[148:151], v17 offset:2048
    ds_read_b128 v[152:155], v17 offset:2560
    ds_read_b128 v[156:159], v17 offset:3072
    ds_read_b128 v[160:163], v17 offset:3584
    s_waitcnt lgkmcnt(0)
    v_add_f32 v28, v28, v136
    v_add_f32 v29, v29, v137
    v_add_f32 v30, v30, v138
    v_add_f32 v31, v31, v139
    v_add_f32 v28, v28, v140
    v_add_f32 v29, v29, v141
    v_add_f32 v30, v30, v142
    v_add_f32 v31, v31, v143
    v_add_f32 v28, v28, v144
    v_add_f32 v29, v29, v145
    v_add_f32 v30, v30, v146
    v_add_f32 v31, v31, v147
    v_add_f32 v28, v28, v148
    v_add_f32 v29, v29, v149
    v_add_f32 v30, v30, v150
    v_add_f32 v31, v31, v151
    v_add_f32 v28, v28, v152
    v_add_f32 v29, v29, v153
    v_add_f32 v30, v30, v154
    v_add_f32 v31, v31, v155
    v_add_f32 v28, v28, v156
    v_add_f32 v29, v29, v157
    v_add_f32 v30, v30, v158
    v_add_f32 v31, v31, v159
    v_add_f32 v28, v28, v160
    v_add_f32 v29, v29, v161
    v_add_f32 v30, v30, v162
    v_add_f32 v31, v31, v163
    v_cvt_pk_bf16_f32 v28, v28, v28
    v_lshlrev_b32 v28, 16, v28
    v_add_f32 v28, v28, v72
    v_cvt_pk_bf16_f32 v29, v29, v29
    v_lshlrev_b32 v29, 16, v29
    v_add_f32 v29, v29, v73
    v_cvt_pk_bf16_f32 v30, v30, v30
    v_lshlrev_b32 v30, 16, v30
    v_add_f32 v30, v30, v74
    v_cvt_pk_bf16_f32 v31, v31, v31
    v_lshlrev_b32 v31, 16, v31
    v_add_f32 v31, v31, v75
    v_cvt_pk_bf16_f32 v28, v28, v29
    v_cvt_pk_bf16_f32 v29, v30, v31
    s_lshl_b32 s57, s15, 8
    s_mov_b32 exec_lo, -1
    s_mov_b32 exec_hi, 0
    buffer_store_dwordx2 v[28:29], v18, s[44:47], s57 offen
    s_mov_b64 exec, -1
    s_branch L_fin
    s_mov_b32 s62, 0
L_z2:
    s_nop 7
    s_nop 3
    s_lshl_b32 s63, s15, 9
    s_add_u32 s63, s63, 786432
    buffer_load_dwordx4 v[36:39], v16, s[24:27], s63 offen sc1
    s_add_u32 s63, s63, 131072
    buffer_load_dwordx4 v[40:43], v16, s[24:27], s63 offen sc1
    s_add_u32 s63, s63, 131072
    buffer_load_dwordx4 v[44:47], v16, s[24:27], s63 offen sc1
    s_add_u32 s63, s63, 131072
    buffer_load_dwordx4 v[48:51], v16, s[24:27], s63 offen sc1
    s_add_u32 s63, s63, 131072
    buffer_load_dwordx4 v[52:55], v16, s[24:27], s63 offen sc1
    s_add_u32 s63, s63, 131072
    buffer_load_dwordx4 v[56:59], v16, s[24:27], s63 offen sc1
    s_add_u32 s63, s63, 131072
    buffer_load_dwordx4 v[60:63], v16, s[24:27], s63 offen sc1
    s_waitcnt vmcnt(0)
    v_max_u32 v10, v36, v37
    v_max3_u32 v10, v38, v39, v10
    v_max3_u32 v10, v40, v41, v10
    v_max3_u32 v10, v42, v43, v10
    v_max3_u32 v10, v44, v45, v10
    v_max3_u32 v10, v46, v47, v10
    v_max3_u32 v10, v48, v49, v10
    v_max3_u32 v10, v50, v51, v10
    v_max3_u32 v10, v52, v53, v10
    v_max3_u32 v10, v54, v55, v10
    v_max3_u32 v10, v56, v57, v10
    v_max3_u32 v10, v58, v59, v10
    v_max3_u32 v10, v60, v61, v10
    v_max3_u32 v10, v62, v63, v10
    v_cmp_eq_u32 vcc, -1, v10
    s_nop 0
    s_cmp_eq_u64 vcc, 0
    s_cbranch_scc1 L_z2_done
    s_sleep 1
    s_add_u32 s62, s62, 1
    s_cmp_lt_u32 s62, 65536
    s_cbranch_scc1 L_z2
L_z2_done:
    s_nop 7
    s_nop 3
    v_add_f32 v36, v36, v40
    v_add_f32 v37, v37, v41
    v_add_f32 v38, v38, v42
    v_add_f32 v39, v39, v43
    v_add_f32 v36, v36, v44
    v_add_f32 v37, v37, v45
    v_add_f32 v38, v38, v46
    v_add_f32 v39, v39, v47
    v_add_f32 v36, v36, v48
    v_add_f32 v37, v37, v49
    v_add_f32 v38, v38, v50
    v_add_f32 v39, v39, v51
    v_add_f32 v36, v36, v52
    v_add_f32 v37, v37, v53
    v_add_f32 v38, v38, v54
    v_add_f32 v39, v39, v55
    v_add_f32 v36, v36, v56
    v_add_f32 v37, v37, v57
    v_add_f32 v38, v38, v58
    v_add_f32 v39, v39, v59
    v_add_f32 v36, v36, v60
    v_add_f32 v37, v37, v61
    v_add_f32 v38, v38, v62
    v_add_f32 v39, v39, v63
    v_lshlrev_b32 v6, 4, v0
    ds_write_b128 v6, v[36:39] offset:0
    s_waitcnt lgkmcnt(0)
    s_barrier
    s_cmp_lg_u32 s3, 0
    s_cbranch_scc1 L_fin
    ds_read_b128 v[80:83], v17 offset:0
    ds_read_b128 v[84:87], v17 offset:512
    ds_read_b128 v[88:91], v17 offset:1024
    ds_read_b128 v[92:95], v17 offset:1536
    ds_read_b128 v[96:99], v17 offset:2048
    ds_read_b128 v[100:103], v17 offset:2560
    ds_read_b128 v[104:107], v17 offset:3072
    ds_read_b128 v[108:111], v17 offset:3584
    ds_read_b128 v[112:115], v17 offset:4096
    ds_read_b128 v[116:119], v17 offset:4608
    ds_read_b128 v[120:123], v17 offset:5120
    ds_read_b128 v[124:127], v17 offset:5632
    ds_read_b128 v[128:131], v17 offset:6144
    ds_read_b128 v[132:135], v17 offset:6656
    ds_read_b128 v[136:139], v17 offset:7168
    ds_read_b128 v[140:143], v17 offset:7680
    s_waitcnt lgkmcnt(0)
    v_add_f32 v80, v80, v84
    v_add_f32 v81, v81, v85
    v_add_f32 v82, v82, v86
    v_add_f32 v83, v83, v87
    v_add_f32 v80, v80, v88
    v_add_f32 v81, v81, v89
    v_add_f32 v82, v82, v90
    v_add_f32 v83, v83, v91
    v_add_f32 v80, v80, v92
    v_add_f32 v81, v81, v93
    v_add_f32 v82, v82, v94
    v_add_f32 v83, v83, v95
    v_add_f32 v80, v80, v96
    v_add_f32 v81, v81, v97
    v_add_f32 v82, v82, v98
    v_add_f32 v83, v83, v99
    v_add_f32 v80, v80, v100
    v_add_f32 v81, v81, v101
    v_add_f32 v82, v82, v102
    v_add_f32 v83, v83, v103
    v_add_f32 v80, v80, v104
    v_add_f32 v81, v81, v105
    v_add_f32 v82, v82, v106
    v_add_f32 v83, v83, v107
    v_add_f32 v80, v80, v108
    v_add_f32 v81, v81, v109
    v_add_f32 v82, v82, v110
    v_add_f32 v83, v83, v111
    v_add_f32 v80, v80, v112
    v_add_f32 v81, v81, v113
    v_add_f32 v82, v82, v114
    v_add_f32 v83, v83, v115
    v_add_f32 v80, v80, v116
    v_add_f32 v81, v81, v117
    v_add_f32 v82, v82, v118
    v_add_f32 v83, v83, v119
    v_add_f32 v80, v80, v120
    v_add_f32 v81, v81, v121
    v_add_f32 v82, v82, v122
    v_add_f32 v83, v83, v123
    v_add_f32 v80, v80, v124
    v_add_f32 v81, v81, v125
    v_add_f32 v82, v82, v126
    v_add_f32 v83, v83, v127
    v_add_f32 v80, v80, v128
    v_add_f32 v81, v81, v129
    v_add_f32 v82, v82, v130
    v_add_f32 v83, v83, v131
    v_add_f32 v80, v80, v132
    v_add_f32 v81, v81, v133
    v_add_f32 v82, v82, v134
    v_add_f32 v83, v83, v135
    v_add_f32 v80, v80, v136
    v_add_f32 v81, v81, v137
    v_add_f32 v82, v82, v138
    v_add_f32 v83, v83, v139
    v_add_f32 v80, v80, v140
    v_add_f32 v81, v81, v141
    v_add_f32 v82, v82, v142
    v_add_f32 v83, v83, v143
    v_cvt_pk_bf16_f32 v80, v80, v80
    v_lshlrev_b32 v80, 16, v80
    v_add_f32 v80, v80, v72
    v_cvt_pk_bf16_f32 v81, v81, v81
    v_lshlrev_b32 v81, 16, v81
    v_add_f32 v81, v81, v73
    v_cvt_pk_bf16_f32 v82, v82, v82
    v_lshlrev_b32 v82, 16, v82
    v_add_f32 v82, v82, v74
    v_cvt_pk_bf16_f32 v83, v83, v83
    v_lshlrev_b32 v83, 16, v83
    v_add_f32 v83, v83, v75
    v_cvt_pk_bf16_f32 v80, v80, v81
    v_cvt_pk_bf16_f32 v81, v82, v83
    s_lshl_b32 s57, s15, 8
    s_mov_b32 exec_lo, -1
    s_mov_b32 exec_hi, 0
    buffer_store_dwordx2 v[80:81], v18, s[44:47], s57 offen
    s_mov_b64 exec, -1
L_fin:
    s_nop 7
    s_nop 3
L_end:
    s_nop 7
    s_nop 3
    s_endpgm
.section .rodata,"a"
.p2align 6
.amdhsa_kernel sequential_preLN__gqa_block_cached__geglu_ffn__decode_kernel
  .amdhsa_next_free_vgpr 164
  .amdhsa_next_free_sgpr 102
  .amdhsa_accum_offset 164
  .amdhsa_group_segment_fixed_size 0
  .amdhsa_kernarg_size 96
  .amdhsa_user_sgpr_count 2
  .amdhsa_user_sgpr_kernarg_segment_ptr 1
  .amdhsa_system_sgpr_workgroup_id_x 1
.end_amdhsa_kernel
```
